```python
import torch

def _softmax(x, axis=-1):
    return torch.softmax(x, dim=axis)
def _gelu(x):
    return torch.nn.functional.gelu(x, approximate="tanh")
def _silu(x):
    return torch.nn.functional.silu(x)
def _sigmoid(x):
    return torch.sigmoid(x)
def _layernorm(x, axis=-1, eps=1e-5):
    m = x.mean(dim=axis, keepdim=True)
    v = x.var(dim=axis, keepdim=True, unbiased=False)
    return (x - m) / torch.sqrt(v + eps)
def _scatter_add(tgt, idx, src, axis=0):
    return tgt.clone().index_add_(axis, idx, src)
def _segment_sum(src, seg, n):
    out = torch.zeros((n,) + src.shape[1:], dtype=src.dtype)
    return out.index_add_(0, seg, src)
def _pad(x, pw):
    flat = tuple(v for pair in reversed(pw) for v in pair)
    return torch.nn.functional.pad(x, flat)

kernel_name = 'gated_mix__grouped_kv_mqa__sliding_block__prompt'

def setup_inputs():

    _w = (lambda a: (lambda t: t.to(torch.bfloat16) if t.is_floating_point() else t)(torch.as_tensor(a)))
    def _A_setup():
        B, S, D, H = 1, 2048, 512, 32
        Dh = D // H
        return {
            "x": _w((lambda *s: torch.randn(*s, dtype=torch.bfloat16) * 0.05)(B, S, D)),
            "wq": _w((lambda *s: torch.randn(*s, dtype=torch.bfloat16) * 1.6)(D, H * Dh)),
            "wk": _w((lambda *s: torch.randn(*s, dtype=torch.bfloat16) * 1.6)(D, Dh)),
            "wv": _w((lambda *s: torch.randn(*s, dtype=torch.bfloat16) * 0.2)(D, Dh)),
            "wo": _w((lambda *s: torch.randn(*s, dtype=torch.bfloat16) * 0.2)(H * Dh, D)),
        }
    _A_in = _A_setup()

    def _B_setup():
        B, S, D = 1, 2048, 512
        return {
            "x": _w((lambda *s: torch.randn(*s, dtype=torch.bfloat16) * 0.05)(B, S, D)),
            "wqkv": _w((lambda *s: torch.randn(*s, dtype=torch.bfloat16) * 1.6)(D, 3 * D)),
            "wo": _w((lambda *s: torch.randn(*s, dtype=torch.bfloat16) * 0.05)(D, D)),
        }
    _B_in = _B_setup()

    return {
        "A_x": _A_in["x"],
        "A_wq": _A_in["wq"],
        "A_wk": _A_in["wk"],
        "A_wv": _A_in["wv"],
        "A_wo": _A_in["wo"],
        "B_x": _B_in["x"],
        "B_wqkv": _B_in["wqkv"],
        "B_wo": _B_in["wo"],
        "gate_w": _w((lambda *s: torch.randn(*s, dtype=torch.bfloat16) * 0.05)(512) * 16.0),
    }

def reference(A_x, A_wq, A_wk, A_wv, A_wo, B_x, B_wqkv, B_wo, gate_w):
    def _A_ref(x, wq, wk, wv, wo):
        B, S, D = x.shape
        H = 32
        Dh = D // H
        q = (lambda x, *d: x.permute(*d))((x @ wq).reshape(B, S, H, Dh), 0, 2, 1, 3)
        k = x @ wk
        v = x @ wv
        scores = torch.einsum("bhqd,bkd->bhqk", q, k) * (Dh ** -0.5)
        p = _softmax(scores, axis=-1)
        o = torch.einsum("bhqk,bkd->bhqd", p, v)
        return (lambda x, *d: x.permute(*d))(o, 0, 2, 1, 3).reshape(B, S, H * Dh) @ wo

    def _B_ref(x, wqkv, wo):
        B, S, D = x.shape
        H = 32; Dh = D // H; W = 256
        qkv = (lambda x, *d: x.permute(*d))((x @ wqkv).reshape(B, S, 3, H, Dh), 2, 0, 3, 1, 4)
        q, k, v = qkv[0], qkv[1], qkv[2]
        scores = torch.einsum("bhqd,bhkd->bhqk", q, k) * (Dh ** -0.5)
        idx = torch.arange(S)
        mask = (idx[:, None] - idx[None, :] >= 0) & (idx[:, None] - idx[None, :] < W)
        scores = torch.where(mask[None, None], scores, -1e9)
        p = _softmax(scores, axis=-1)
        o = torch.einsum("bhqk,bhkd->bhqd", p, v)
        return (lambda x, *d: x.permute(*d))(o, 0, 2, 1, 3).reshape(B, S, D) @ wo

    x = A_x
    g = _sigmoid((x * gate_w).sum(-1, keepdims=True))
    a = _A_ref(x, A_wq, A_wk, A_wv, A_wo)
    b = _B_ref(x, B_wqkv, B_wo)
    return g * a + (1 - g) * b
```

```asm
; @launch grid=(256,1,1) block=(512,1,1) lds=163840
.amdgcn_target "amdgcn-amd-amdhsa--gfx950"
.text
.globl gated_mix__grouped_kv_mqa__sliding_block__prompt_kernel
.p2align 8
.type gated_mix__grouped_kv_mqa__sliding_block__prompt_kernel,@function
gated_mix__grouped_kv_mqa__sliding_block__prompt_kernel:
    s_cmp_ge_u32 s2, 256
    s_cbranch_scc1 L_exit
    v_lshrrev_b32 v4, 6, v0
    v_and_b32 v1, 63, v0
    v_readfirstlane_b32 s16, v4
    v_lshlrev_b32 v5, 2, v1
    s_cmp_lg_u32 s16, 3
    s_cbranch_scc1 L_nozero
    v_mov_b32 v4, 0
    v_add_u32 v5, 156672, v5
    ds_write_b32 v5, v4
    s_waitcnt lgkmcnt(0)
L_nozero:
    s_load_dwordx16 s[44:59], s[0:1], 0
    s_load_dwordx8 s[60:67], s[0:1], 64
    s_memrealtime s[22:23]
    s_and_b32 s17, s2, 1
    s_lshl_b32 s17, s17, 2
    s_bfe_u32 s24, s2, 0x10003
    s_add_u32 s17, s17, s24
    s_lshr_b32 s24, s2, 7
    s_lshl_b32 s24, s24, 1
    s_add_u32 s17, s17, s24
    s_bfe_u32 s18, s2, 0x20001
    s_lshl_b32 s18, s18, 3
    s_bfe_u32 s24, s2, 0x30004
    s_add_u32 s18, s18, s24
    v_lshlrev_b32 v2, 4, v1
    s_barrier
    s_lshr_b32 s24, s16, 2
    s_xor_b32 s24, s24, s17
    s_and_b32 s24, s24, 1
    s_xor_b32 s24, s24, 1
    s_lshl_b32 s24, s24, 2
    s_and_b32 s28, s16, 3
    s_add_u32 s24, s24, s28
    s_lshl_b32 s27, s24, 10
    s_lshl_b32 s24, s24, 3
    v_lshrrev_b32 v4, 3, v1
    v_add_u32 v4, s24, v4
    v_lshrrev_b32 v5, 1, v4
    v_xor_b32 v5, v5, v1
    v_and_b32 v5, 7, v5
    v_lshlrev_b32 v5, 4, v5
    v_lshl_add_u32 v7, v4, 10, v5
    s_lshl_b32 s33, s18, 16
    s_and_b32 s37, s17, 2
    s_add_u32 s37, s37, 4
    s_cmp_lt_u32 s16, 4
    s_cbranch_scc1 L_ateam
L_bteam:
    s_setprio 2
    s_lshl_b32 s35, s28, 10
    s_mov_b32 s6, 0x200000
    s_mov_b32 s7, 0x00020000
    s_bitcmp0_b32 s17, 1
    s_cselect_b32 s42, 16384, 0
    s_mov_b32 s43, 0x00020000
    s_or_b32 s26, s2, s28
    s_cmp_lt_u32 s17, 4
    s_waitcnt lgkmcnt(0)
    s_cselect_b32 s40, s48, s50
    s_cselect_b32 s41, s49, s51
    s_mov_b32 s4, s44
    s_and_b32 s5, s45, 0xffff
    s_and_b32 s41, s41, 0xffff
    s_add_u32 m0, s27, 24192
    s_nop 0
    buffer_load_dwordx4 v7, s[4:7], s33 offen offset:384 lds
    s_add_u32 m0, s35, 131072
    s_add_u32 s24, s35, 0
    buffer_load_dwordx4 v2, s[40:43], s24 offen lds
    s_add_u32 m0, s27, 0
    s_nop 0
    buffer_load_dwordx4 v7, s[4:7], s33 offen offset:0 lds
    s_add_u32 m0, s27, 8064
    s_nop 0
    buffer_load_dwordx4 v7, s[4:7], s33 offen offset:128 lds
    s_add_u32 m0, s35, 135168
    s_add_u32 s24, s35, 4096
    buffer_load_dwordx4 v2, s[40:43], s24 offen lds
    s_add_u32 m0, s27, 16128
    s_nop 0
    buffer_load_dwordx4 v7, s[4:7], s33 offen offset:256 lds
    s_add_u32 m0, s27, 32256
    s_nop 0
    buffer_load_dwordx4 v7, s[4:7], s33 offen offset:512 lds
    s_add_u32 m0, s35, 139264
    s_add_u32 s24, s35, 8192
    buffer_load_dwordx4 v2, s[40:43], s24 offen lds
    s_add_u32 m0, s27, 40320
    s_nop 0
    buffer_load_dwordx4 v7, s[4:7], s33 offen offset:640 lds
    s_add_u32 m0, s27, 48384
    s_nop 0
    buffer_load_dwordx4 v7, s[4:7], s33 offen offset:768 lds
    s_add_u32 m0, s35, 143360
    s_add_u32 s24, s35, 12288
    buffer_load_dwordx4 v2, s[40:43], s24 offen lds
    s_add_u32 m0, s27, 56448
    s_nop 0
    buffer_load_dwordx4 v7, s[4:7], s33 offen offset:896 lds
    s_or_b32 s25, s22, 1
    s_mov_b32 s3, s22
    s_mov_b32 s20, s64
    s_and_b32 s21, s65, 0xffff
    s_mov_b32 s22, 0x100
    s_mov_b32 s23, 0x00020000
    s_mov_b32 s12, s66
    s_and_b32 s13, s67, 0xffff
    s_mov_b32 s14, 0x1000000
    s_mov_b32 s15, 0x00020000
    s_cmp_lg_u32 s26, 1
    s_cbranch_scc1 L_b_nononce
    s_cmp_lg_u32 s2, 0
    s_cbranch_scc1 L_b_nononce
    v_mov_b32 v4, s25
    v_mov_b32 v5, 0
    s_mov_b64 exec, 1
    buffer_store_dword v4, v5, s[20:23], 0 offen sc1
    s_mov_b64 exec, -1
L_b_nononce:
    s_cmp_lg_u32 s28, 3
    s_cbranch_scc1 L_b_notouch
    v_lshlrev_b32 v4, 21, v1
    s_lshl_b32 s25, s2, 7
    s_add_u32 s25, s25, 0x3f800
    v_writelane_b32 v4, s25, 5
    s_add_u32 s25, s25, 0x10000
    v_writelane_b32 v4, s25, 6
    s_mov_b64 exec, 127
    buffer_load_dword v254, v4, s[12:15], 0 offen offset:2048 sc1
    s_mov_b64 exec, -1
L_b_notouch:
    s_and_b32 s27, s17, 1
    s_lshl_b32 s25, s27, 12
    v_and_b32 v4, 31, v1
    v_lshrrev_b32 v5, 5, v1
    v_bfe_u32 v6, v1, 1, 3
    v_xor_b32 v5, v5, v6
    v_lshl_add_u32 v4, v4, 7, s25
    v_xor_b32 v6, 0, v5
    v_lshl_add_u32 v9, v6, 4, v4
    v_xor_b32 v6, 2, v5
    v_lshl_add_u32 v10, v6, 4, v4
    v_xor_b32 v6, 4, v5
    v_lshl_add_u32 v11, v6, 4, v4
    v_xor_b32 v6, 6, v5
    v_lshl_add_u32 v12, v6, 4, v4
    s_mov_b32 s25, 131072
    v_lshrrev_b32 v4, 5, v1
    v_bfe_u32 v5, v1, 2, 2
    v_mad_u32_u24 v4, v4, 8, v5
    v_and_b32 v5, 3, v1
    v_lshlrev_b32 v5, 3, v5
    v_lshl_add_u32 v13, v4, 5, v5
    v_add_u32 v13, s25, v13
    v_and_b32 v4, 31, v1
    v_lshrrev_b32 v5, 5, v1
    v_lshlrev_b32 v5, 8, v5
    v_lshl_add_u32 v3, v4, 4, v5
    v_add_u32 v3, 1024, v3
    v_mov_b32 v5, 0x40000000
    v_cmp_gt_u32 s[38:39], 16, v4
    v_and_b32 v4, 27, v4
    v_mov_b32 v6, 2048
    v_cndmask_b32_e64 v3, v5, v3, s[38:39]
    v_cmp_eq_u32 s[38:39], 16, v4
    v_add_u32 v0, 512, v3
    s_nop 0
    v_cndmask_b32_e64 v3, v3, v6, s[38:39]
    v_cndmask_b32_e64 v0, v0, v6, s[38:39]
    v_mov_b32 v15, 0
    s_lshl_b32 s32, s18, 1
    s_add_u32 s33, s32, s27
    s_mul_i32 s33, s33, 2176
    s_lshl_b32 s34, s18, 2
    s_add_u32 s34, s34, s27
    s_lshr_b32 s25, s17, 2
    s_lshl_b32 s25, s25, 1
    s_add_u32 s34, s34, s25
    s_lshl_b32 s34, s34, 5
    s_add_u32 s34, s34, 0x50000
    s_waitcnt vmcnt(6)
    s_cmp_lg_u32 s28, 0
    s_cbranch_scc1 L_b_idle
    s_bitcmp1_b32 s17, 1
    s_cbranch_scc1 L_b_idle
    s_cmp_ge_u32 s17, 4
    s_cbranch_scc1 L_b_vunit
    v_mov_b32 v4, 156688
    s_mov_b32 s36, 400000
tw_16:
    ds_read_b32 v5, v4
    s_waitcnt lgkmcnt(0)
    v_readfirstlane_b32 s24, v5
    s_nop 1
    s_cmp_ge_u32 s24, 3
    s_cbranch_scc1 twd_17
    s_sub_u32 s36, s36, 1
    s_cbranch_scc1 twd_17
    s_branch tw_16
twd_17:
    ds_read_b64_tr_b16 v[64:65], v13 offset:0
    ds_read_b64_tr_b16 v[66:67], v13 offset:128
    ds_read_b128 v[68:71], v9 offset:0
    ds_read_b64_tr_b16 v[72:73], v13 offset:512
    ds_read_b64_tr_b16 v[74:75], v13 offset:640
    ds_read_b128 v[76:79], v10 offset:0
    ds_read_b64_tr_b16 v[80:81], v13 offset:1024
    ds_read_b64_tr_b16 v[82:83], v13 offset:1152
    ds_read_b128 v[84:87], v11 offset:0
    ds_read_b64_tr_b16 v[88:89], v13 offset:1536
    ds_read_b64_tr_b16 v[90:91], v13 offset:1664
    ds_read_b128 v[92:95], v12 offset:0
    s_waitcnt lgkmcnt(9)
    v_mfma_f32_32x32x16_bf16 v[16:31], v[64:67], v[68:71], 0
    ds_read_b64_tr_b16 v[64:65], v13 offset:2048
    ds_read_b64_tr_b16 v[66:67], v13 offset:2176
    ds_read_b128 v[68:71], v9 offset:8192
    s_waitcnt lgkmcnt(9)
    v_mfma_f32_32x32x16_bf16 v[16:31], v[72:75], v[76:79], v[16:31]
    ds_read_b64_tr_b16 v[72:73], v13 offset:2560
    ds_read_b64_tr_b16 v[74:75], v13 offset:2688
    ds_read_b128 v[76:79], v10 offset:8192
    s_waitcnt lgkmcnt(9)
    v_mfma_f32_32x32x16_bf16 v[16:31], v[80:83], v[84:87], v[16:31]
    ds_read_b64_tr_b16 v[80:81], v13 offset:3072
    ds_read_b64_tr_b16 v[82:83], v13 offset:3200
    ds_read_b128 v[84:87], v11 offset:8192
    s_waitcnt lgkmcnt(9)
    v_mfma_f32_32x32x16_bf16 v[16:31], v[88:91], v[92:95], v[16:31]
    ds_read_b64_tr_b16 v[88:89], v13 offset:3584
    ds_read_b64_tr_b16 v[90:91], v13 offset:3712
    ds_read_b128 v[92:95], v12 offset:8192
    s_waitcnt lgkmcnt(9)
    v_mfma_f32_32x32x16_bf16 v[16:31], v[64:67], v[68:71], v[16:31]
    ds_read_b64_tr_b16 v[64:65], v13 offset:4096
    ds_read_b64_tr_b16 v[66:67], v13 offset:4224
    ds_read_b128 v[68:71], v9 offset:16384
    s_waitcnt lgkmcnt(9)
    v_mfma_f32_32x32x16_bf16 v[16:31], v[72:75], v[76:79], v[16:31]
    ds_read_b64_tr_b16 v[72:73], v13 offset:4608
    ds_read_b64_tr_b16 v[74:75], v13 offset:4736
    ds_read_b128 v[76:79], v10 offset:16384
    s_waitcnt lgkmcnt(9)
    v_mfma_f32_32x32x16_bf16 v[16:31], v[80:83], v[84:87], v[16:31]
    ds_read_b64_tr_b16 v[80:81], v13 offset:5120
    ds_read_b64_tr_b16 v[82:83], v13 offset:5248
    ds_read_b128 v[84:87], v11 offset:16384
    s_waitcnt lgkmcnt(9)
    v_mfma_f32_32x32x16_bf16 v[16:31], v[88:91], v[92:95], v[16:31]
    ds_read_b64_tr_b16 v[88:89], v13 offset:5632
    ds_read_b64_tr_b16 v[90:91], v13 offset:5760
    ds_read_b128 v[92:95], v12 offset:16384
    s_waitcnt lgkmcnt(9)
    v_mfma_f32_32x32x16_bf16 v[16:31], v[64:67], v[68:71], v[16:31]
    ds_read_b64_tr_b16 v[64:65], v13 offset:6144
    ds_read_b64_tr_b16 v[66:67], v13 offset:6272
    ds_read_b128 v[68:71], v9 offset:24576
    s_waitcnt lgkmcnt(9)
    v_mfma_f32_32x32x16_bf16 v[16:31], v[72:75], v[76:79], v[16:31]
    ds_read_b64_tr_b16 v[72:73], v13 offset:6656
    ds_read_b64_tr_b16 v[74:75], v13 offset:6784
    ds_read_b128 v[76:79], v10 offset:24576
    s_waitcnt lgkmcnt(9)
    v_mfma_f32_32x32x16_bf16 v[16:31], v[80:83], v[84:87], v[16:31]
    ds_read_b64_tr_b16 v[80:81], v13 offset:7168
    ds_read_b64_tr_b16 v[82:83], v13 offset:7296
    ds_read_b128 v[84:87], v11 offset:24576
    s_waitcnt lgkmcnt(9)
    v_mfma_f32_32x32x16_bf16 v[16:31], v[88:91], v[92:95], v[16:31]
    ds_read_b64_tr_b16 v[88:89], v13 offset:7680
    ds_read_b64_tr_b16 v[90:91], v13 offset:7808
    ds_read_b128 v[92:95], v12 offset:24576
    s_waitcnt lgkmcnt(9)
    v_mfma_f32_32x32x16_bf16 v[16:31], v[64:67], v[68:71], v[16:31]
    s_waitcnt lgkmcnt(6)
    v_mfma_f32_32x32x16_bf16 v[16:31], v[72:75], v[76:79], v[16:31]
    s_waitcnt lgkmcnt(3)
    v_mfma_f32_32x32x16_bf16 v[16:31], v[80:83], v[84:87], v[16:31]
    s_waitcnt lgkmcnt(0)
    v_mfma_f32_32x32x16_bf16 v[16:31], v[88:91], v[92:95], v[16:31]
    s_waitcnt vmcnt(0)
    buffer_load_dword v14, v15, s[20:23], 0 offen sc1
    v_mov_b32 v4, 156704
    s_mov_b32 s36, 400000
tw_18:
    ds_read_b32 v5, v4
    s_waitcnt lgkmcnt(0)
    v_readfirstlane_b32 s24, v5
    s_nop 1
    s_cmp_ge_u32 s24, 3
    s_cbranch_scc1 twd_19
    s_sub_u32 s36, s36, 1
    s_cbranch_scc1 twd_19
    s_branch tw_18
twd_19:
    v_mov_b32 v4, 156692
    v_mov_b32 v5, 1
    s_mov_b64 exec, 1
    ds_add_u32 v4, v5
    s_mov_b64 exec, -1
    ds_read_b64_tr_b16 v[64:65], v13 offset:8192
    ds_read_b64_tr_b16 v[66:67], v13 offset:8320
    ds_read_b128 v[68:71], v9 offset:32768
    ds_read_b64_tr_b16 v[72:73], v13 offset:8704
    ds_read_b64_tr_b16 v[74:75], v13 offset:8832
    ds_read_b128 v[76:79], v10 offset:32768
    ds_read_b64_tr_b16 v[80:81], v13 offset:9216
    ds_read_b64_tr_b16 v[82:83], v13 offset:9344
    ds_read_b128 v[84:87], v11 offset:32768
    ds_read_b64_tr_b16 v[88:89], v13 offset:9728
    ds_read_b64_tr_b16 v[90:91], v13 offset:9856
    ds_read_b128 v[92:95], v12 offset:32768
    s_waitcnt lgkmcnt(9)
    v_mfma_f32_32x32x16_bf16 v[16:31], v[64:67], v[68:71], v[16:31]
    ds_read_b64_tr_b16 v[64:65], v13 offset:10240
    ds_read_b64_tr_b16 v[66:67], v13 offset:10368
    ds_read_b128 v[68:71], v9 offset:40960
    s_waitcnt lgkmcnt(9)
    v_mfma_f32_32x32x16_bf16 v[16:31], v[72:75], v[76:79], v[16:31]
    ds_read_b64_tr_b16 v[72:73], v13 offset:10752
    ds_read_b64_tr_b16 v[74:75], v13 offset:10880
    ds_read_b128 v[76:79], v10 offset:40960
    s_waitcnt lgkmcnt(9)
    v_mfma_f32_32x32x16_bf16 v[16:31], v[80:83], v[84:87], v[16:31]
    ds_read_b64_tr_b16 v[80:81], v13 offset:11264
    ds_read_b64_tr_b16 v[82:83], v13 offset:11392
    ds_read_b128 v[84:87], v11 offset:40960
    s_waitcnt lgkmcnt(9)
    v_mfma_f32_32x32x16_bf16 v[16:31], v[88:91], v[92:95], v[16:31]
    ds_read_b64_tr_b16 v[88:89], v13 offset:11776
    ds_read_b64_tr_b16 v[90:91], v13 offset:11904
    ds_read_b128 v[92:95], v12 offset:40960
    s_waitcnt lgkmcnt(9)
    v_mfma_f32_32x32x16_bf16 v[16:31], v[64:67], v[68:71], v[16:31]
    ds_read_b64_tr_b16 v[64:65], v13 offset:12288
    ds_read_b64_tr_b16 v[66:67], v13 offset:12416
    ds_read_b128 v[68:71], v9 offset:49152
    s_waitcnt lgkmcnt(9)
    v_mfma_f32_32x32x16_bf16 v[16:31], v[72:75], v[76:79], v[16:31]
    ds_read_b64_tr_b16 v[72:73], v13 offset:12800
    ds_read_b64_tr_b16 v[74:75], v13 offset:12928
    ds_read_b128 v[76:79], v10 offset:49152
    s_waitcnt lgkmcnt(9)
    v_mfma_f32_32x32x16_bf16 v[16:31], v[80:83], v[84:87], v[16:31]
    ds_read_b64_tr_b16 v[80:81], v13 offset:13312
    ds_read_b64_tr_b16 v[82:83], v13 offset:13440
    ds_read_b128 v[84:87], v11 offset:49152
    s_waitcnt lgkmcnt(9)
    v_mfma_f32_32x32x16_bf16 v[16:31], v[88:91], v[92:95], v[16:31]
    ds_read_b64_tr_b16 v[88:89], v13 offset:13824
    ds_read_b64_tr_b16 v[90:91], v13 offset:13952
    ds_read_b128 v[92:95], v12 offset:49152
    s_waitcnt lgkmcnt(9)
    v_mfma_f32_32x32x16_bf16 v[16:31], v[64:67], v[68:71], v[16:31]
    ds_read_b64_tr_b16 v[64:65], v13 offset:14336
    ds_read_b64_tr_b16 v[66:67], v13 offset:14464
    ds_read_b128 v[68:71], v9 offset:57344
    s_waitcnt lgkmcnt(9)
    v_mfma_f32_32x32x16_bf16 v[16:31], v[72:75], v[76:79], v[16:31]
    ds_read_b64_tr_b16 v[72:73], v13 offset:14848
    ds_read_b64_tr_b16 v[74:75], v13 offset:14976
    ds_read_b128 v[76:79], v10 offset:57344
    s_waitcnt lgkmcnt(9)
    v_mfma_f32_32x32x16_bf16 v[16:31], v[80:83], v[84:87], v[16:31]
    ds_read_b64_tr_b16 v[80:81], v13 offset:15360
    ds_read_b64_tr_b16 v[82:83], v13 offset:15488
    ds_read_b128 v[84:87], v11 offset:57344
    s_waitcnt lgkmcnt(9)
    v_mfma_f32_32x32x16_bf16 v[16:31], v[88:91], v[92:95], v[16:31]
    ds_read_b64_tr_b16 v[88:89], v13 offset:15872
    ds_read_b64_tr_b16 v[90:91], v13 offset:16000
    ds_read_b128 v[92:95], v12 offset:57344
    s_waitcnt lgkmcnt(9)
    v_mfma_f32_32x32x16_bf16 v[16:31], v[64:67], v[68:71], v[16:31]
    s_waitcnt lgkmcnt(6)
    v_mfma_f32_32x32x16_bf16 v[16:31], v[72:75], v[76:79], v[16:31]
    s_waitcnt lgkmcnt(3)
    v_mfma_f32_32x32x16_bf16 v[16:31], v[80:83], v[84:87], v[16:31]
    s_waitcnt lgkmcnt(0)
    v_mfma_f32_32x32x16_bf16 v[16:31], v[88:91], v[92:95], v[16:31]
    s_nop 7
    s_nop 3
    v_cvt_pk_bf16_f32 v64, v16, v17
    v_cvt_pk_bf16_f32 v65, v18, v19
    v_cvt_pk_bf16_f32 v66, v20, v21
    v_cvt_pk_bf16_f32 v67, v22, v23
    buffer_store_dwordx4 v[64:67], v2, s[12:15], s33 offen sc1
    s_branch L_b_kvpub
L_b_vunit:
    v_lshrrev_b32 v5, 5, v1
    v_lshlrev_b32 v7, 8, v5
    v_and_b32 v5, 15, v1
    v_lshl_add_u32 v7, v5, 4, v7
    v_bfe_u32 v5, v1, 4, 1
    v_lshl_add_u32 v7, v5, 30, v7
    v_cmp_gt_u32 s[38:39], 8, v1
    v_mov_b32 v5, 0x40000000
    v_mov_b32 v100, 0x3f803f80
    v_mov_b32 v101, 0x3f803f80
    v_mov_b32 v102, 0x3f803f80
    v_mov_b32 v103, 0x3f803f80
    v_cndmask_b32_e64 v8, v5, v2, s[38:39]
    v_mov_b32 v4, 156688
    s_mov_b32 s36, 400000
tw_20:
    ds_read_b32 v5, v4
    s_waitcnt lgkmcnt(0)
    v_readfirstlane_b32 s24, v5
    s_nop 1
    s_cmp_ge_u32 s24, 3
    s_cbranch_scc1 twd_21
    s_sub_u32 s36, s36, 1
    s_cbranch_scc1 twd_21
    s_branch tw_20
twd_21:
    ds_read_b64_tr_b16 v[64:65], v13 offset:0
    ds_read_b64_tr_b16 v[66:67], v13 offset:128
    ds_read_b128 v[68:71], v9 offset:0
    ds_read_b64_tr_b16 v[72:73], v13 offset:512
    ds_read_b64_tr_b16 v[74:75], v13 offset:640
    ds_read_b128 v[76:79], v10 offset:0
    ds_read_b64_tr_b16 v[80:81], v13 offset:1024
    ds_read_b64_tr_b16 v[82:83], v13 offset:1152
    ds_read_b128 v[84:87], v11 offset:0
    ds_read_b64_tr_b16 v[88:89], v13 offset:1536
    ds_read_b64_tr_b16 v[90:91], v13 offset:1664
    ds_read_b128 v[92:95], v12 offset:0
    s_waitcnt lgkmcnt(9)
    v_mfma_f32_32x32x16_bf16 v[16:31], v[68:71], v[64:67], 0
    ds_read_b64_tr_b16 v[64:65], v13 offset:2048
    ds_read_b64_tr_b16 v[66:67], v13 offset:2176
    ds_read_b128 v[68:71], v9 offset:8192
    s_waitcnt lgkmcnt(9)
    v_mfma_f32_32x32x16_bf16 v[16:31], v[76:79], v[72:75], v[16:31]
    ds_read_b64_tr_b16 v[72:73], v13 offset:2560
    ds_read_b64_tr_b16 v[74:75], v13 offset:2688
    ds_read_b128 v[76:79], v10 offset:8192
    s_waitcnt lgkmcnt(9)
    v_mfma_f32_32x32x16_bf16 v[16:31], v[84:87], v[80:83], v[16:31]
    ds_read_b64_tr_b16 v[80:81], v13 offset:3072
    ds_read_b64_tr_b16 v[82:83], v13 offset:3200
    ds_read_b128 v[84:87], v11 offset:8192
    s_waitcnt lgkmcnt(9)
    v_mfma_f32_32x32x16_bf16 v[16:31], v[92:95], v[88:91], v[16:31]
    ds_read_b64_tr_b16 v[88:89], v13 offset:3584
    ds_read_b64_tr_b16 v[90:91], v13 offset:3712
    ds_read_b128 v[92:95], v12 offset:8192
    s_waitcnt lgkmcnt(9)
    v_mfma_f32_32x32x16_bf16 v[16:31], v[68:71], v[64:67], v[16:31]
    ds_read_b64_tr_b16 v[64:65], v13 offset:4096
    ds_read_b64_tr_b16 v[66:67], v13 offset:4224
    ds_read_b128 v[68:71], v9 offset:16384
    s_waitcnt lgkmcnt(9)
    v_mfma_f32_32x32x16_bf16 v[16:31], v[76:79], v[72:75], v[16:31]
    ds_read_b64_tr_b16 v[72:73], v13 offset:4608
    ds_read_b64_tr_b16 v[74:75], v13 offset:4736
    ds_read_b128 v[76:79], v10 offset:16384
    s_waitcnt lgkmcnt(9)
    v_mfma_f32_32x32x16_bf16 v[16:31], v[84:87], v[80:83], v[16:31]
    ds_read_b64_tr_b16 v[80:81], v13 offset:5120
    ds_read_b64_tr_b16 v[82:83], v13 offset:5248
    ds_read_b128 v[84:87], v11 offset:16384
    s_waitcnt lgkmcnt(9)
    v_mfma_f32_32x32x16_bf16 v[16:31], v[92:95], v[88:91], v[16:31]
    ds_read_b64_tr_b16 v[88:89], v13 offset:5632
    ds_read_b64_tr_b16 v[90:91], v13 offset:5760
    ds_read_b128 v[92:95], v12 offset:16384
    s_waitcnt lgkmcnt(9)
    v_mfma_f32_32x32x16_bf16 v[16:31], v[68:71], v[64:67], v[16:31]
    ds_read_b64_tr_b16 v[64:65], v13 offset:6144
    ds_read_b64_tr_b16 v[66:67], v13 offset:6272
    ds_read_b128 v[68:71], v9 offset:24576
    s_waitcnt lgkmcnt(9)
    v_mfma_f32_32x32x16_bf16 v[16:31], v[76:79], v[72:75], v[16:31]
    ds_read_b64_tr_b16 v[72:73], v13 offset:6656
    ds_read_b64_tr_b16 v[74:75], v13 offset:6784
    ds_read_b128 v[76:79], v10 offset:24576
    s_waitcnt lgkmcnt(9)
    v_mfma_f32_32x32x16_bf16 v[16:31], v[84:87], v[80:83], v[16:31]
    ds_read_b64_tr_b16 v[80:81], v13 offset:7168
    ds_read_b64_tr_b16 v[82:83], v13 offset:7296
    ds_read_b128 v[84:87], v11 offset:24576
    s_waitcnt lgkmcnt(9)
    v_mfma_f32_32x32x16_bf16 v[16:31], v[92:95], v[88:91], v[16:31]
    ds_read_b64_tr_b16 v[88:89], v13 offset:7680
    ds_read_b64_tr_b16 v[90:91], v13 offset:7808
    ds_read_b128 v[92:95], v12 offset:24576
    s_waitcnt lgkmcnt(9)
    v_mfma_f32_32x32x16_bf16 v[16:31], v[68:71], v[64:67], v[16:31]
    s_waitcnt lgkmcnt(6)
    v_mfma_f32_32x32x16_bf16 v[16:31], v[76:79], v[72:75], v[16:31]
    s_waitcnt lgkmcnt(3)
    v_mfma_f32_32x32x16_bf16 v[16:31], v[84:87], v[80:83], v[16:31]
    s_waitcnt lgkmcnt(0)
    v_mfma_f32_32x32x16_bf16 v[16:31], v[92:95], v[88:91], v[16:31]
    s_waitcnt vmcnt(0)
    buffer_load_dword v14, v15, s[20:23], 0 offen sc1
    buffer_store_dwordx4 v[100:103], v8, s[12:15], s33 offen offset:2048 sc1
    v_mov_b32 v4, 156704
    s_mov_b32 s36, 400000
tw_22:
    ds_read_b32 v5, v4
    s_waitcnt lgkmcnt(0)
    v_readfirstlane_b32 s24, v5
    s_nop 1
    s_cmp_ge_u32 s24, 3
    s_cbranch_scc1 twd_23
    s_sub_u32 s36, s36, 1
    s_cbranch_scc1 twd_23
    s_branch tw_22
twd_23:
    v_mov_b32 v4, 156692
    v_mov_b32 v5, 1
    s_mov_b64 exec, 1
    ds_add_u32 v4, v5
    s_mov_b64 exec, -1
    ds_read_b64_tr_b16 v[64:65], v13 offset:8192
    ds_read_b64_tr_b16 v[66:67], v13 offset:8320
    ds_read_b128 v[68:71], v9 offset:32768
    ds_read_b64_tr_b16 v[72:73], v13 offset:8704
    ds_read_b64_tr_b16 v[74:75], v13 offset:8832
    ds_read_b128 v[76:79], v10 offset:32768
    ds_read_b64_tr_b16 v[80:81], v13 offset:9216
    ds_read_b64_tr_b16 v[82:83], v13 offset:9344
    ds_read_b128 v[84:87], v11 offset:32768
    ds_read_b64_tr_b16 v[88:89], v13 offset:9728
    ds_read_b64_tr_b16 v[90:91], v13 offset:9856
    ds_read_b128 v[92:95], v12 offset:32768
    s_waitcnt lgkmcnt(9)
    v_mfma_f32_32x32x16_bf16 v[16:31], v[68:71], v[64:67], v[16:31]
    ds_read_b64_tr_b16 v[64:65], v13 offset:10240
    ds_read_b64_tr_b16 v[66:67], v13 offset:10368
    ds_read_b128 v[68:71], v9 offset:40960
    s_waitcnt lgkmcnt(9)
    v_mfma_f32_32x32x16_bf16 v[16:31], v[76:79], v[72:75], v[16:31]
    ds_read_b64_tr_b16 v[72:73], v13 offset:10752
    ds_read_b64_tr_b16 v[74:75], v13 offset:10880
    ds_read_b128 v[76:79], v10 offset:40960
    s_waitcnt lgkmcnt(9)
    v_mfma_f32_32x32x16_bf16 v[16:31], v[84:87], v[80:83], v[16:31]
    ds_read_b64_tr_b16 v[80:81], v13 offset:11264
    ds_read_b64_tr_b16 v[82:83], v13 offset:11392
    ds_read_b128 v[84:87], v11 offset:40960
    s_waitcnt lgkmcnt(9)
    v_mfma_f32_32x32x16_bf16 v[16:31], v[92:95], v[88:91], v[16:31]
    ds_read_b64_tr_b16 v[88:89], v13 offset:11776
    ds_read_b64_tr_b16 v[90:91], v13 offset:11904
    ds_read_b128 v[92:95], v12 offset:40960
    s_waitcnt lgkmcnt(9)
    v_mfma_f32_32x32x16_bf16 v[16:31], v[68:71], v[64:67], v[16:31]
    ds_read_b64_tr_b16 v[64:65], v13 offset:12288
    ds_read_b64_tr_b16 v[66:67], v13 offset:12416
    ds_read_b128 v[68:71], v9 offset:49152
    s_waitcnt lgkmcnt(9)
    v_mfma_f32_32x32x16_bf16 v[16:31], v[76:79], v[72:75], v[16:31]
    ds_read_b64_tr_b16 v[72:73], v13 offset:12800
    ds_read_b64_tr_b16 v[74:75], v13 offset:12928
    ds_read_b128 v[76:79], v10 offset:49152
    s_waitcnt lgkmcnt(9)
    v_mfma_f32_32x32x16_bf16 v[16:31], v[84:87], v[80:83], v[16:31]
    ds_read_b64_tr_b16 v[80:81], v13 offset:13312
    ds_read_b64_tr_b16 v[82:83], v13 offset:13440
    ds_read_b128 v[84:87], v11 offset:49152
    s_waitcnt lgkmcnt(9)
    v_mfma_f32_32x32x16_bf16 v[16:31], v[92:95], v[88:91], v[16:31]
    ds_read_b64_tr_b16 v[88:89], v13 offset:13824
    ds_read_b64_tr_b16 v[90:91], v13 offset:13952
    ds_read_b128 v[92:95], v12 offset:49152
    s_waitcnt lgkmcnt(9)
    v_mfma_f32_32x32x16_bf16 v[16:31], v[68:71], v[64:67], v[16:31]
    ds_read_b64_tr_b16 v[64:65], v13 offset:14336
    ds_read_b64_tr_b16 v[66:67], v13 offset:14464
    ds_read_b128 v[68:71], v9 offset:57344
    s_waitcnt lgkmcnt(9)
    v_mfma_f32_32x32x16_bf16 v[16:31], v[76:79], v[72:75], v[16:31]
    ds_read_b64_tr_b16 v[72:73], v13 offset:14848
    ds_read_b64_tr_b16 v[74:75], v13 offset:14976
    ds_read_b128 v[76:79], v10 offset:57344
    s_waitcnt lgkmcnt(9)
    v_mfma_f32_32x32x16_bf16 v[16:31], v[84:87], v[80:83], v[16:31]
    ds_read_b64_tr_b16 v[80:81], v13 offset:15360
    ds_read_b64_tr_b16 v[82:83], v13 offset:15488
    ds_read_b128 v[84:87], v11 offset:57344
    s_waitcnt lgkmcnt(9)
    v_mfma_f32_32x32x16_bf16 v[16:31], v[92:95], v[88:91], v[16:31]
    ds_read_b64_tr_b16 v[88:89], v13 offset:15872
    ds_read_b64_tr_b16 v[90:91], v13 offset:16000
    ds_read_b128 v[92:95], v12 offset:57344
    s_waitcnt lgkmcnt(9)
    v_mfma_f32_32x32x16_bf16 v[16:31], v[68:71], v[64:67], v[16:31]
    s_waitcnt lgkmcnt(6)
    v_mfma_f32_32x32x16_bf16 v[16:31], v[76:79], v[72:75], v[16:31]
    s_waitcnt lgkmcnt(3)
    v_mfma_f32_32x32x16_bf16 v[16:31], v[84:87], v[80:83], v[16:31]
    s_waitcnt lgkmcnt(0)
    v_mfma_f32_32x32x16_bf16 v[16:31], v[92:95], v[88:91], v[16:31]
    s_nop 7
    s_nop 3
    v_cvt_pk_bf16_f32 v64, v16, v17
    v_cvt_pk_bf16_f32 v65, v18, v19
    v_cvt_pk_bf16_f32 v66, v20, v21
    v_cvt_pk_bf16_f32 v67, v22, v23
    s_nop 1
    v_permlane32_swap_b32 v64, v66
    v_permlane32_swap_b32 v65, v67
    buffer_store_dwordx4 v[64:67], v7, s[12:15], s33 offen offset:1024 sc1
    v_cvt_pk_bf16_f32 v68, v24, v25
    v_cvt_pk_bf16_f32 v69, v26, v27
    v_cvt_pk_bf16_f32 v70, v28, v29
    v_cvt_pk_bf16_f32 v71, v30, v31
    s_nop 1
    v_permlane32_swap_b32 v68, v70
    v_permlane32_swap_b32 v69, v71
    buffer_store_dwordx4 v[68:71], v7, s[12:15], s33 offen offset:1536 sc1
L_b_kvpub:
    s_mov_b32 s36, 400000
nw_24:
    s_waitcnt vmcnt(0)
    v_readfirstlane_b32 s19, v14
    s_nop 1
    s_cmp_eq_u32 s19, 0
    s_cbranch_scc1 nwr_26
    s_sub_u32 s24, s3, s19
    s_cmp_lt_i32 s24, 1000
    s_cbranch_scc1 nwd_25
    s_cmp_lt_u32 s36, 399936
    s_cbranch_scc1 nwd_25
nwr_26:
    s_sub_u32 s36, s36, 1
    s_cbranch_scc1 nwd_25
    buffer_load_dword v14, v15, s[20:23], 0 offen sc1
    s_branch nw_24
nwd_25:
    v_mov_b32 v4, s19
    v_lshlrev_b32 v5, 12, v1
    s_mov_b64 exec, 255
    buffer_store_dword v4, v5, s[12:15], s34 offen sc1
    s_mov_b64 exec, -1
    s_branch L_b_pdone
L_b_idle:
    v_mov_b32 v4, 156688
    v_mov_b32 v5, 1
    s_mov_b64 exec, 1
    ds_add_u32 v4, v5
    s_mov_b64 exec, -1
    s_cmp_eq_u32 s28, 3
    s_cbranch_scc1 L_b_idle1
    s_waitcnt vmcnt(0)
L_b_idle1:
    s_waitcnt vmcnt(1)
    buffer_load_dword v14, v15, s[20:23], 0 offen sc1
    v_mov_b32 v4, 156692
    v_mov_b32 v5, 1
    s_mov_b64 exec, 1
    ds_add_u32 v4, v5
    s_mov_b64 exec, -1
    v_mov_b32 v4, 156704
    v_mov_b32 v5, 1
    s_mov_b64 exec, 1
    ds_add_u32 v4, v5
    s_mov_b64 exec, -1
    s_mov_b32 s36, 400000
nw_27:
    s_waitcnt vmcnt(0)
    v_readfirstlane_b32 s19, v14
    s_nop 1
    s_cmp_eq_u32 s19, 0
    s_cbranch_scc1 nwr_29
    s_sub_u32 s24, s3, s19
    s_cmp_lt_i32 s24, 1000
    s_cbranch_scc1 nwd_28
    s_cmp_lt_u32 s36, 399936
    s_cbranch_scc1 nwd_28
nwr_29:
    s_sub_u32 s36, s36, 1
    s_cbranch_scc1 nwd_28
    buffer_load_dword v14, v15, s[20:23], 0 offen sc1
    s_branch nw_27
nwd_28:
    v_mov_b32 v4, 156736
    ds_write_b32 v4, v14
L_b_pdone:
    s_mov_b32 s8, s56
    s_and_b32 s9, s57, 0xffff
    s_mov_b32 s10, 0x180000
    s_mov_b32 s11, 0x00020000
    s_mov_b32 s40, s60
    s_and_b32 s41, s61, 0xffff
    s_mov_b32 s42, 0x400
    s_mov_b32 s43, 0x00020000
    s_mov_b32 m0, 155648
    s_lshl_b32 s31, s17, 2
    buffer_load_dwordx4 v2, s[40:43], 0 offen lds
    s_add_u32 s31, s31, s28
    v_lshrrev_b32 v4, 3, v1
    v_mul_u32_u24 v4, 3072, v4
    v_lshrrev_b32 v5, 2, v1
    v_and_b32 v5, 4, v5
    v_xor_b32 v5, v5, v1
    v_and_b32 v5, 7, v5
    v_lshl_add_u32 v7, v5, 4, v4
    s_lshl_b32 s33, s28, 10
    s_lshl_b32 s25, s17, 7
    s_add_u32 s33, s33, s25
    s_lshl_b32 s34, s28, 14
    s_add_u32 s34, s34, 65536
    s_add_u32 s37, s33, 1572864
    s_and_b32 s26, s18, 3
    s_cmp_eq_u32 s28, 3
    s_cselect_b32 s26, 0, s26
    s_lshl_b32 s25, s26, 14
    s_mul_i32 s26, s26, 393216
    s_add_u32 s33, s33, s26
    v_and_b32 v4, 31, v1
    v_lshrrev_b32 v5, 5, v1
    v_bfe_u32 v6, v1, 1, 3
    v_xor_b32 v5, v5, v6
    v_lshl_add_u32 v4, v4, 7, s25
    v_xor_b32 v6, 0, v5
    v_lshl_add_u32 v9, v6, 4, v4
    v_xor_b32 v6, 2, v5
    v_lshl_add_u32 v10, v6, 4, v4
    v_xor_b32 v6, 4, v5
    v_lshl_add_u32 v11, v6, 4, v4
    v_xor_b32 v6, 6, v5
    v_lshl_add_u32 v12, v6, 4, v4
    v_lshrrev_b32 v4, 5, v1
    v_bfe_u32 v5, v1, 2, 2
    v_mad_u32_u24 v4, v4, 8, v5
    v_and_b32 v5, 3, v1
    v_lshlrev_b32 v5, 3, v5
    v_lshl_add_u32 v4, v4, 7, v5
    v_bfe_u32 v5, v1, 4, 1
    v_lshl_add_u32 v4, v5, 5, v4
    v_bfe_u32 v5, v1, 3, 1
    v_lshl_add_u32 v4, v5, 6, v4
    v_add_u32 v13, s34, v4
    v_xor_b32 v8, 64, v13
    v_pk_mov_b32 v[16:17], 0, 0
    v_pk_mov_b32 v[18:19], 0, 0
    v_pk_mov_b32 v[20:21], 0, 0
    v_pk_mov_b32 v[22:23], 0, 0
    v_pk_mov_b32 v[24:25], 0, 0
    v_pk_mov_b32 v[26:27], 0, 0
    v_pk_mov_b32 v[28:29], 0, 0
    v_pk_mov_b32 v[30:31], 0, 0
    v_pk_mov_b32 v[32:33], 0, 0
    v_pk_mov_b32 v[34:35], 0, 0
    v_pk_mov_b32 v[36:37], 0, 0
    v_pk_mov_b32 v[38:39], 0, 0
    v_pk_mov_b32 v[40:41], 0, 0
    v_pk_mov_b32 v[42:43], 0, 0
    v_pk_mov_b32 v[44:45], 0, 0
    v_pk_mov_b32 v[46:47], 0, 0
    v_pk_mov_b32 v[48:49], 0, 0
    v_pk_mov_b32 v[50:51], 0, 0
    v_pk_mov_b32 v[52:53], 0, 0
    v_pk_mov_b32 v[54:55], 0, 0
    v_pk_mov_b32 v[56:57], 0, 0
    v_pk_mov_b32 v[58:59], 0, 0
    v_pk_mov_b32 v[60:61], 0, 0
    v_pk_mov_b32 v[62:63], 0, 0
    v_pk_mov_b32 v[64:65], 0, 0
    v_pk_mov_b32 v[66:67], 0, 0
    v_pk_mov_b32 v[68:69], 0, 0
    v_pk_mov_b32 v[70:71], 0, 0
    v_pk_mov_b32 v[72:73], 0, 0
    v_pk_mov_b32 v[74:75], 0, 0
    v_pk_mov_b32 v[76:77], 0, 0
    v_pk_mov_b32 v[78:79], 0, 0
    s_mov_b32 s30, 4
    s_cmp_eq_u32 s28, 3
    s_cbranch_scc1 L_b_gwave
    s_cmp_lg_u32 s28, 1
    s_cbranch_scc1 L_b_notw
    v_lshlrev_b32 v4, 16, v1
    buffer_load_dword v254, v4, s[8:11], 0 offen sc1
    s_mov_b32 s40, s58
    s_and_b32 s41, s59, 0xffff
    s_mov_b32 s42, 0x80000
    s_mov_b32 s43, 0x00020000
    buffer_load_dword v254, v4, s[40:43], 0 offen sc1
    s_mov_b32 s40, s52
    s_and_b32 s41, s53, 0xffff
    s_mov_b32 s42, 0x80000
    s_mov_b32 s43, 0x00020000
    buffer_load_dword v254, v4, s[40:43], 0 offen sc1
L_b_notw:
    v_mov_b32 v4, 156700
    s_mov_b32 s36, 400000
tw_30:
    ds_read_b32 v5, v4
    s_waitcnt lgkmcnt(0)
    v_readfirstlane_b32 s24, v5
    s_nop 1
    s_cmp_ge_u32 s24, 4
    s_cbranch_scc1 twd_31
    s_sub_u32 s36, s36, 1
    s_cbranch_scc1 twd_31
    s_sleep 2
    s_branch tw_30
twd_31:
    s_add_u32 m0, s34, 0
    s_add_u32 s25, s33, 24576
    buffer_load_dwordx4 v7, s[8:11], s33 offen lds
    s_add_u32 m0, s34, 1024
    s_add_u32 s33, s33, 49152
    buffer_load_dwordx4 v7, s[8:11], s25 offen lds
    s_add_u32 m0, s34, 2048
    s_add_u32 s25, s33, 24576
    buffer_load_dwordx4 v7, s[8:11], s33 offen lds
    s_add_u32 m0, s34, 3072
    s_add_u32 s33, s33, 49152
    buffer_load_dwordx4 v7, s[8:11], s25 offen lds
    s_add_u32 m0, s34, 4096
    s_add_u32 s25, s33, 24576
    buffer_load_dwordx4 v7, s[8:11], s33 offen lds
    s_add_u32 m0, s34, 5120
    s_add_u32 s33, s33, 49152
    buffer_load_dwordx4 v7, s[8:11], s25 offen lds
    s_add_u32 m0, s34, 6144
    s_add_u32 s25, s33, 24576
    buffer_load_dwordx4 v7, s[8:11], s33 offen lds
    s_add_u32 m0, s34, 7168
    s_add_u32 s33, s33, 49152
    buffer_load_dwordx4 v7, s[8:11], s25 offen lds
    s_cmp_eq_u32 s28, 2
    s_cbranch_scc1 L_p3v
L_p3qk:
    s_waitcnt vmcnt(6)
    ds_read_b64_tr_b16 v[80:81], v13 offset:0
    ds_read_b64_tr_b16 v[82:83], v13 offset:512
    ds_read_b128 v[88:91], v9 offset:0
    s_waitcnt lgkmcnt(0)
    v_mfma_f32_32x32x16_bf16 v[16:31], v[80:83], v[88:91], v[16:31]
    ds_read_b128 v[92:95], v9 offset:4096
    s_waitcnt lgkmcnt(0)
    v_mfma_f32_32x32x16_bf16 v[32:47], v[80:83], v[92:95], v[32:47]
    ds_read_b64_tr_b16 v[84:85], v8 offset:0
    ds_read_b64_tr_b16 v[86:87], v8 offset:512
    s_waitcnt lgkmcnt(0)
    v_mfma_f32_32x32x16_bf16 v[64:79], v[84:87], v[92:95], v[64:79]
    s_add_u32 m0, s34, 8192
    s_add_u32 s25, s33, 24576
    buffer_load_dwordx4 v7, s[8:11], s33 offen lds
    s_add_u32 m0, s34, 9216
    s_add_u32 s33, s33, 49152
    buffer_load_dwordx4 v7, s[8:11], s25 offen lds
    v_mfma_f32_32x32x16_bf16 v[48:63], v[84:87], v[88:91], v[48:63]
    s_waitcnt vmcnt(6)
    ds_read_b64_tr_b16 v[80:81], v13 offset:2048
    ds_read_b64_tr_b16 v[82:83], v13 offset:2560
    ds_read_b128 v[88:91], v10 offset:0
    s_waitcnt lgkmcnt(0)
    v_mfma_f32_32x32x16_bf16 v[16:31], v[80:83], v[88:91], v[16:31]
    ds_read_b128 v[92:95], v10 offset:4096
    s_waitcnt lgkmcnt(0)
    v_mfma_f32_32x32x16_bf16 v[32:47], v[80:83], v[92:95], v[32:47]
    ds_read_b64_tr_b16 v[84:85], v8 offset:2048
    ds_read_b64_tr_b16 v[86:87], v8 offset:2560
    s_waitcnt lgkmcnt(0)
    v_mfma_f32_32x32x16_bf16 v[64:79], v[84:87], v[92:95], v[64:79]
    s_add_u32 m0, s34, 10240
    s_add_u32 s25, s33, 24576
    buffer_load_dwordx4 v7, s[8:11], s33 offen lds
    s_add_u32 m0, s34, 11264
    s_add_u32 s33, s33, 49152
    buffer_load_dwordx4 v7, s[8:11], s25 offen lds
    v_mfma_f32_32x32x16_bf16 v[48:63], v[84:87], v[88:91], v[48:63]
    s_waitcnt vmcnt(6)
    ds_read_b64_tr_b16 v[80:81], v13 offset:4096
    ds_read_b64_tr_b16 v[82:83], v13 offset:4608
    ds_read_b128 v[88:91], v11 offset:0
    s_waitcnt lgkmcnt(0)
    v_mfma_f32_32x32x16_bf16 v[16:31], v[80:83], v[88:91], v[16:31]
    ds_read_b128 v[92:95], v11 offset:4096
    s_waitcnt lgkmcnt(0)
    v_mfma_f32_32x32x16_bf16 v[32:47], v[80:83], v[92:95], v[32:47]
    ds_read_b64_tr_b16 v[84:85], v8 offset:4096
    ds_read_b64_tr_b16 v[86:87], v8 offset:4608
    s_waitcnt lgkmcnt(0)
    v_mfma_f32_32x32x16_bf16 v[64:79], v[84:87], v[92:95], v[64:79]
    s_add_u32 m0, s34, 12288
    s_add_u32 s25, s33, 24576
    buffer_load_dwordx4 v7, s[8:11], s33 offen lds
    s_add_u32 m0, s34, 13312
    s_add_u32 s33, s33, 49152
    buffer_load_dwordx4 v7, s[8:11], s25 offen lds
    v_mfma_f32_32x32x16_bf16 v[48:63], v[84:87], v[88:91], v[48:63]
    s_waitcnt vmcnt(6)
    ds_read_b64_tr_b16 v[80:81], v13 offset:6144
    ds_read_b64_tr_b16 v[82:83], v13 offset:6656
    ds_read_b128 v[88:91], v12 offset:0
    s_waitcnt lgkmcnt(0)
    v_mfma_f32_32x32x16_bf16 v[16:31], v[80:83], v[88:91], v[16:31]
    ds_read_b128 v[92:95], v12 offset:4096
    s_waitcnt lgkmcnt(0)
    v_mfma_f32_32x32x16_bf16 v[32:47], v[80:83], v[92:95], v[32:47]
    ds_read_b64_tr_b16 v[84:85], v8 offset:6144
    ds_read_b64_tr_b16 v[86:87], v8 offset:6656
    s_waitcnt lgkmcnt(0)
    v_mfma_f32_32x32x16_bf16 v[64:79], v[84:87], v[92:95], v[64:79]
    s_add_u32 m0, s34, 14336
    s_add_u32 s25, s33, 24576
    buffer_load_dwordx4 v7, s[8:11], s33 offen lds
    s_add_u32 m0, s34, 15360
    s_add_u32 s33, s33, 49152
    buffer_load_dwordx4 v7, s[8:11], s25 offen lds
    v_mfma_f32_32x32x16_bf16 v[48:63], v[84:87], v[88:91], v[48:63]
    s_waitcnt vmcnt(6)
    ds_read_b64_tr_b16 v[80:81], v13 offset:8192
    ds_read_b64_tr_b16 v[82:83], v13 offset:8704
    ds_read_b128 v[88:91], v9 offset:8192
    s_waitcnt lgkmcnt(0)
    v_mfma_f32_32x32x16_bf16 v[16:31], v[80:83], v[88:91], v[16:31]
    ds_read_b128 v[92:95], v9 offset:12288
    s_waitcnt lgkmcnt(0)
    v_mfma_f32_32x32x16_bf16 v[32:47], v[80:83], v[92:95], v[32:47]
    ds_read_b64_tr_b16 v[84:85], v8 offset:8192
    ds_read_b64_tr_b16 v[86:87], v8 offset:8704
    s_waitcnt lgkmcnt(0)
    v_mfma_f32_32x32x16_bf16 v[64:79], v[84:87], v[92:95], v[64:79]
    s_cmp_ge_u32 s33, s37
    s_cselect_b32 s25, 1572864, 0
    s_sub_u32 s33, s33, s25
    s_cmp_eq_u32 s30, 1
    s_cselect_b32 s33, 0x40000000, s33
    s_add_u32 m0, s34, 0
    s_add_u32 s25, s33, 24576
    buffer_load_dwordx4 v7, s[8:11], s33 offen lds
    s_add_u32 m0, s34, 1024
    s_add_u32 s33, s33, 49152
    buffer_load_dwordx4 v7, s[8:11], s25 offen lds
    v_mfma_f32_32x32x16_bf16 v[48:63], v[84:87], v[88:91], v[48:63]
    s_waitcnt vmcnt(6)
    ds_read_b64_tr_b16 v[80:81], v13 offset:10240
    ds_read_b64_tr_b16 v[82:83], v13 offset:10752
    ds_read_b128 v[88:91], v10 offset:8192
    s_waitcnt lgkmcnt(0)
    v_mfma_f32_32x32x16_bf16 v[16:31], v[80:83], v[88:91], v[16:31]
    ds_read_b128 v[92:95], v10 offset:12288
    s_waitcnt lgkmcnt(0)
    v_mfma_f32_32x32x16_bf16 v[32:47], v[80:83], v[92:95], v[32:47]
    ds_read_b64_tr_b16 v[84:85], v8 offset:10240
    ds_read_b64_tr_b16 v[86:87], v8 offset:10752
    s_waitcnt lgkmcnt(0)
    v_mfma_f32_32x32x16_bf16 v[64:79], v[84:87], v[92:95], v[64:79]
    s_add_u32 m0, s34, 2048
    s_add_u32 s25, s33, 24576
    buffer_load_dwordx4 v7, s[8:11], s33 offen lds
    s_add_u32 m0, s34, 3072
    s_add_u32 s33, s33, 49152
    buffer_load_dwordx4 v7, s[8:11], s25 offen lds
    v_mfma_f32_32x32x16_bf16 v[48:63], v[84:87], v[88:91], v[48:63]
    s_waitcnt vmcnt(6)
    ds_read_b64_tr_b16 v[80:81], v13 offset:12288
    ds_read_b64_tr_b16 v[82:83], v13 offset:12800
    ds_read_b128 v[88:91], v11 offset:8192
    s_waitcnt lgkmcnt(0)
    v_mfma_f32_32x32x16_bf16 v[16:31], v[80:83], v[88:91], v[16:31]
    ds_read_b128 v[92:95], v11 offset:12288
    s_waitcnt lgkmcnt(0)
    v_mfma_f32_32x32x16_bf16 v[32:47], v[80:83], v[92:95], v[32:47]
    ds_read_b64_tr_b16 v[84:85], v8 offset:12288
    ds_read_b64_tr_b16 v[86:87], v8 offset:12800
    s_waitcnt lgkmcnt(0)
    v_mfma_f32_32x32x16_bf16 v[64:79], v[84:87], v[92:95], v[64:79]
    s_add_u32 m0, s34, 4096
    s_add_u32 s25, s33, 24576
    buffer_load_dwordx4 v7, s[8:11], s33 offen lds
    s_add_u32 m0, s34, 5120
    s_add_u32 s33, s33, 49152
    buffer_load_dwordx4 v7, s[8:11], s25 offen lds
    v_mfma_f32_32x32x16_bf16 v[48:63], v[84:87], v[88:91], v[48:63]
    s_waitcnt vmcnt(6)
    ds_read_b64_tr_b16 v[80:81], v13 offset:14336
    ds_read_b64_tr_b16 v[82:83], v13 offset:14848
    ds_read_b128 v[88:91], v12 offset:8192
    s_waitcnt lgkmcnt(0)
    v_mfma_f32_32x32x16_bf16 v[16:31], v[80:83], v[88:91], v[16:31]
    ds_read_b128 v[92:95], v12 offset:12288
    s_waitcnt lgkmcnt(0)
    v_mfma_f32_32x32x16_bf16 v[32:47], v[80:83], v[92:95], v[32:47]
    ds_read_b64_tr_b16 v[84:85], v8 offset:14336
    ds_read_b64_tr_b16 v[86:87], v8 offset:14848
    s_waitcnt lgkmcnt(0)
    v_mfma_f32_32x32x16_bf16 v[64:79], v[84:87], v[92:95], v[64:79]
    s_add_u32 m0, s34, 6144
    s_add_u32 s25, s33, 24576
    buffer_load_dwordx4 v7, s[8:11], s33 offen lds
    s_add_u32 m0, s34, 7168
    s_add_u32 s33, s33, 49152
    buffer_load_dwordx4 v7, s[8:11], s25 offen lds
    v_mfma_f32_32x32x16_bf16 v[48:63], v[84:87], v[88:91], v[48:63]
    v_add_u32 v9, 16384, v9
    v_and_b32 v9, 0xffff, v9
    v_add_u32 v10, 16384, v10
    v_and_b32 v10, 0xffff, v10
    v_add_u32 v11, 16384, v11
    v_and_b32 v11, 0xffff, v11
    v_add_u32 v12, 16384, v12
    v_and_b32 v12, 0xffff, v12
    s_sub_u32 s30, s30, 1
    s_cmp_lg_u32 s30, 0
    s_cbranch_scc1 L_p3qk
    s_lshl_b32 s29, s17, 8
    s_add_u32 s29, s29, s32
    s_mul_i32 s29, s29, 2176
    s_add_u32 s29, s29, 0x100000
    s_mov_b32 s25, 0x3eb8aa3b
    v_add_u32 v6, 147456, v2
    s_waitcnt lgkmcnt(0)
    s_cmp_eq_u32 s28, 1
    s_cbranch_scc1 L_p3k
    v_mov_b32 v4, 156700
    s_mov_b32 s36, 400000
tw_32:
    ds_read_b32 v5, v4
    s_waitcnt lgkmcnt(0)
    v_readfirstlane_b32 s24, v5
    s_nop 1
    s_cmp_ge_u32 s24, 4
    s_cbranch_scc1 twd_33
    s_sub_u32 s36, s36, 1
    s_cbranch_scc1 twd_33
    s_sleep 2
    s_branch tw_32
twd_33:
    v_mul_f32 v16, s25, v16
    v_mul_f32 v17, s25, v17
    v_mul_f32 v18, s25, v18
    v_mul_f32 v19, s25, v19
    v_mul_f32 v20, s25, v20
    v_mul_f32 v21, s25, v21
    v_mul_f32 v22, s25, v22
    v_mul_f32 v23, s25, v23
    v_cvt_pk_bf16_f32 v80, v16, v17
    v_cvt_pk_bf16_f32 v81, v18, v19
    v_cvt_pk_bf16_f32 v82, v20, v21
    v_cvt_pk_bf16_f32 v83, v22, v23
    ds_write_b128 v6, v[80:83] offset:0
    v_mul_f32 v24, s25, v24
    v_mul_f32 v25, s25, v25
    v_mul_f32 v26, s25, v26
    v_mul_f32 v27, s25, v27
    v_mul_f32 v28, s25, v28
    v_mul_f32 v29, s25, v29
    v_mul_f32 v30, s25, v30
    v_mul_f32 v31, s25, v31
    v_cvt_pk_bf16_f32 v84, v24, v25
    v_cvt_pk_bf16_f32 v85, v26, v27
    v_cvt_pk_bf16_f32 v86, v28, v29
    v_cvt_pk_bf16_f32 v87, v30, v31
    ds_write_b128 v6, v[84:87] offset:1024
    v_mul_f32 v32, s25, v32
    v_mul_f32 v33, s25, v33
    v_mul_f32 v34, s25, v34
    v_mul_f32 v35, s25, v35
    v_mul_f32 v36, s25, v36
    v_mul_f32 v37, s25, v37
    v_mul_f32 v38, s25, v38
    v_mul_f32 v39, s25, v39
    v_cvt_pk_bf16_f32 v88, v32, v33
    v_cvt_pk_bf16_f32 v89, v34, v35
    v_cvt_pk_bf16_f32 v90, v36, v37
    v_cvt_pk_bf16_f32 v91, v38, v39
    ds_write_b128 v6, v[88:91] offset:4096
    v_mul_f32 v40, s25, v40
    v_mul_f32 v41, s25, v41
    v_mul_f32 v42, s25, v42
    v_mul_f32 v43, s25, v43
    v_mul_f32 v44, s25, v44
    v_mul_f32 v45, s25, v45
    v_mul_f32 v46, s25, v46
    v_mul_f32 v47, s25, v47
    v_cvt_pk_bf16_f32 v92, v40, v41
    v_cvt_pk_bf16_f32 v93, v42, v43
    v_cvt_pk_bf16_f32 v94, v44, v45
    v_cvt_pk_bf16_f32 v95, v46, v47
    ds_write_b128 v6, v[92:95] offset:5120
    s_waitcnt lgkmcnt(0)
    v_mul_f32 v48, s25, v48
    v_mul_f32 v49, s25, v49
    v_mul_f32 v50, s25, v50
    v_mul_f32 v51, s25, v51
    v_mul_f32 v52, s25, v52
    v_mul_f32 v53, s25, v53
    v_mul_f32 v54, s25, v54
    v_mul_f32 v55, s25, v55
    v_cvt_pk_bf16_f32 v80, v48, v49
    v_cvt_pk_bf16_f32 v81, v50, v51
    v_cvt_pk_bf16_f32 v82, v52, v53
    v_cvt_pk_bf16_f32 v83, v54, v55
    ds_write_b128 v6, v[80:83] offset:2048
    v_mul_f32 v56, s25, v56
    v_mul_f32 v57, s25, v57
    v_mul_f32 v58, s25, v58
    v_mul_f32 v59, s25, v59
    v_mul_f32 v60, s25, v60
    v_mul_f32 v61, s25, v61
    v_mul_f32 v62, s25, v62
    v_mul_f32 v63, s25, v63
    v_cvt_pk_bf16_f32 v84, v56, v57
    v_cvt_pk_bf16_f32 v85, v58, v59
    v_cvt_pk_bf16_f32 v86, v60, v61
    v_cvt_pk_bf16_f32 v87, v62, v63
    ds_write_b128 v6, v[84:87] offset:3072
    v_mul_f32 v64, s25, v64
    v_mul_f32 v65, s25, v65
    v_mul_f32 v66, s25, v66
    v_mul_f32 v67, s25, v67
    v_mul_f32 v68, s25, v68
    v_mul_f32 v69, s25, v69
    v_mul_f32 v70, s25, v70
    v_mul_f32 v71, s25, v71
    v_cvt_pk_bf16_f32 v88, v64, v65
    v_cvt_pk_bf16_f32 v89, v66, v67
    v_cvt_pk_bf16_f32 v90, v68, v69
    v_cvt_pk_bf16_f32 v91, v70, v71
    ds_write_b128 v6, v[88:91] offset:6144
    v_mul_f32 v72, s25, v72
    v_mul_f32 v73, s25, v73
    v_mul_f32 v74, s25, v74
    v_mul_f32 v75, s25, v75
    v_mul_f32 v76, s25, v76
    v_mul_f32 v77, s25, v77
    v_mul_f32 v78, s25, v78
    v_mul_f32 v79, s25, v79
    v_cvt_pk_bf16_f32 v92, v72, v73
    v_cvt_pk_bf16_f32 v93, v74, v75
    v_cvt_pk_bf16_f32 v94, v76, v77
    v_cvt_pk_bf16_f32 v95, v78, v79
    ds_write_b128 v6, v[92:95] offset:7168
    s_waitcnt vmcnt(0) lgkmcnt(0)
    s_branch L_p3done
L_p3k:
    v_cvt_pk_bf16_f32 v80, v16, v17
    v_cvt_pk_bf16_f32 v81, v18, v19
    v_cvt_pk_bf16_f32 v82, v20, v21
    v_cvt_pk_bf16_f32 v83, v22, v23
    buffer_store_dwordx4 v[80:83], v2, s[12:15], s29 offen offset:0 sc1
    v_cvt_pk_bf16_f32 v84, v32, v33
    v_cvt_pk_bf16_f32 v85, v34, v35
    v_cvt_pk_bf16_f32 v86, v36, v37
    v_cvt_pk_bf16_f32 v87, v38, v39
    buffer_store_dwordx4 v[84:87], v2, s[12:15], s29 offen offset:2176 sc1
    s_add_u32 s29, s29, 139264
    v_cvt_pk_bf16_f32 v88, v24, v25
    v_cvt_pk_bf16_f32 v89, v26, v27
    v_cvt_pk_bf16_f32 v90, v28, v29
    v_cvt_pk_bf16_f32 v91, v30, v31
    buffer_store_dwordx4 v[88:91], v2, s[12:15], s29 offen offset:0 sc1
    v_cvt_pk_bf16_f32 v92, v40, v41
    v_cvt_pk_bf16_f32 v93, v42, v43
    v_cvt_pk_bf16_f32 v94, v44, v45
    v_cvt_pk_bf16_f32 v95, v46, v47
    buffer_store_dwordx4 v[92:95], v2, s[12:15], s29 offen offset:2176 sc1
    s_add_u32 s29, s29, 139264
    v_cvt_pk_bf16_f32 v96, v48, v49
    v_cvt_pk_bf16_f32 v97, v50, v51
    v_cvt_pk_bf16_f32 v98, v52, v53
    v_cvt_pk_bf16_f32 v99, v54, v55
    buffer_store_dwordx4 v[96:99], v2, s[12:15], s29 offen offset:0 sc1
    v_cvt_pk_bf16_f32 v100, v64, v65
    v_cvt_pk_bf16_f32 v101, v66, v67
    v_cvt_pk_bf16_f32 v102, v68, v69
    v_cvt_pk_bf16_f32 v103, v70, v71
    buffer_store_dwordx4 v[100:103], v2, s[12:15], s29 offen offset:2176 sc1
    s_add_u32 s29, s29, 139264
    v_cvt_pk_bf16_f32 v104, v56, v57
    v_cvt_pk_bf16_f32 v105, v58, v59
    v_cvt_pk_bf16_f32 v106, v60, v61
    v_cvt_pk_bf16_f32 v107, v62, v63
    buffer_store_dwordx4 v[104:107], v2, s[12:15], s29 offen offset:0 sc1
    v_cvt_pk_bf16_f32 v108, v72, v73
    v_cvt_pk_bf16_f32 v109, v74, v75
    v_cvt_pk_bf16_f32 v110, v76, v77
    v_cvt_pk_bf16_f32 v111, v78, v79
    buffer_store_dwordx4 v[108:111], v2, s[12:15], s29 offen offset:2176 sc1
    s_add_u32 s29, s29, 139264
    s_branch L_p3pub
L_p3v:
L_p3vl:
    s_waitcnt vmcnt(6)
    ds_read_b64_tr_b16 v[80:81], v13 offset:0
    ds_read_b64_tr_b16 v[82:83], v13 offset:512
    ds_read_b128 v[88:91], v9 offset:0
    s_waitcnt lgkmcnt(0)
    v_mfma_f32_32x32x16_bf16 v[16:31], v[88:91], v[80:83], v[16:31]
    ds_read_b128 v[92:95], v9 offset:4096
    s_waitcnt lgkmcnt(0)
    v_mfma_f32_32x32x16_bf16 v[32:47], v[92:95], v[80:83], v[32:47]
    ds_read_b64_tr_b16 v[84:85], v8 offset:0
    ds_read_b64_tr_b16 v[86:87], v8 offset:512
    s_waitcnt lgkmcnt(0)
    v_mfma_f32_32x32x16_bf16 v[64:79], v[92:95], v[84:87], v[64:79]
    s_add_u32 m0, s34, 8192
    s_add_u32 s25, s33, 24576
    buffer_load_dwordx4 v7, s[8:11], s33 offen lds
    s_add_u32 m0, s34, 9216
    s_add_u32 s33, s33, 49152
    buffer_load_dwordx4 v7, s[8:11], s25 offen lds
    v_mfma_f32_32x32x16_bf16 v[48:63], v[88:91], v[84:87], v[48:63]
    s_waitcnt vmcnt(6)
    ds_read_b64_tr_b16 v[80:81], v13 offset:2048
    ds_read_b64_tr_b16 v[82:83], v13 offset:2560
    ds_read_b128 v[88:91], v10 offset:0
    s_waitcnt lgkmcnt(0)
    v_mfma_f32_32x32x16_bf16 v[16:31], v[88:91], v[80:83], v[16:31]
    ds_read_b128 v[92:95], v10 offset:4096
    s_waitcnt lgkmcnt(0)
    v_mfma_f32_32x32x16_bf16 v[32:47], v[92:95], v[80:83], v[32:47]
    ds_read_b64_tr_b16 v[84:85], v8 offset:2048
    ds_read_b64_tr_b16 v[86:87], v8 offset:2560
    s_waitcnt lgkmcnt(0)
    v_mfma_f32_32x32x16_bf16 v[64:79], v[92:95], v[84:87], v[64:79]
    s_add_u32 m0, s34, 10240
    s_add_u32 s25, s33, 24576
    buffer_load_dwordx4 v7, s[8:11], s33 offen lds
    s_add_u32 m0, s34, 11264
    s_add_u32 s33, s33, 49152
    buffer_load_dwordx4 v7, s[8:11], s25 offen lds
    v_mfma_f32_32x32x16_bf16 v[48:63], v[88:91], v[84:87], v[48:63]
    s_waitcnt vmcnt(6)
    ds_read_b64_tr_b16 v[80:81], v13 offset:4096
    ds_read_b64_tr_b16 v[82:83], v13 offset:4608
    ds_read_b128 v[88:91], v11 offset:0
    s_waitcnt lgkmcnt(0)
    v_mfma_f32_32x32x16_bf16 v[16:31], v[88:91], v[80:83], v[16:31]
    ds_read_b128 v[92:95], v11 offset:4096
    s_waitcnt lgkmcnt(0)
    v_mfma_f32_32x32x16_bf16 v[32:47], v[92:95], v[80:83], v[32:47]
    ds_read_b64_tr_b16 v[84:85], v8 offset:4096
    ds_read_b64_tr_b16 v[86:87], v8 offset:4608
    s_waitcnt lgkmcnt(0)
    v_mfma_f32_32x32x16_bf16 v[64:79], v[92:95], v[84:87], v[64:79]
    s_add_u32 m0, s34, 12288
    s_add_u32 s25, s33, 24576
    buffer_load_dwordx4 v7, s[8:11], s33 offen lds
    s_add_u32 m0, s34, 13312
    s_add_u32 s33, s33, 49152
    buffer_load_dwordx4 v7, s[8:11], s25 offen lds
    v_mfma_f32_32x32x16_bf16 v[48:63], v[88:91], v[84:87], v[48:63]
    s_waitcnt vmcnt(6)
    ds_read_b64_tr_b16 v[80:81], v13 offset:6144
    ds_read_b64_tr_b16 v[82:83], v13 offset:6656
    ds_read_b128 v[88:91], v12 offset:0
    s_waitcnt lgkmcnt(0)
    v_mfma_f32_32x32x16_bf16 v[16:31], v[88:91], v[80:83], v[16:31]
    ds_read_b128 v[92:95], v12 offset:4096
    s_waitcnt lgkmcnt(0)
    v_mfma_f32_32x32x16_bf16 v[32:47], v[92:95], v[80:83], v[32:47]
    ds_read_b64_tr_b16 v[84:85], v8 offset:6144
    ds_read_b64_tr_b16 v[86:87], v8 offset:6656
    s_waitcnt lgkmcnt(0)
    v_mfma_f32_32x32x16_bf16 v[64:79], v[92:95], v[84:87], v[64:79]
    s_add_u32 m0, s34, 14336
    s_add_u32 s25, s33, 24576
    buffer_load_dwordx4 v7, s[8:11], s33 offen lds
    s_add_u32 m0, s34, 15360
    s_add_u32 s33, s33, 49152
    buffer_load_dwordx4 v7, s[8:11], s25 offen lds
    v_mfma_f32_32x32x16_bf16 v[48:63], v[88:91], v[84:87], v[48:63]
    s_waitcnt vmcnt(6)
    ds_read_b64_tr_b16 v[80:81], v13 offset:8192
    ds_read_b64_tr_b16 v[82:83], v13 offset:8704
    ds_read_b128 v[88:91], v9 offset:8192
    s_waitcnt lgkmcnt(0)
    v_mfma_f32_32x32x16_bf16 v[16:31], v[88:91], v[80:83], v[16:31]
    ds_read_b128 v[92:95], v9 offset:12288
    s_waitcnt lgkmcnt(0)
    v_mfma_f32_32x32x16_bf16 v[32:47], v[92:95], v[80:83], v[32:47]
    ds_read_b64_tr_b16 v[84:85], v8 offset:8192
    ds_read_b64_tr_b16 v[86:87], v8 offset:8704
    s_waitcnt lgkmcnt(0)
    v_mfma_f32_32x32x16_bf16 v[64:79], v[92:95], v[84:87], v[64:79]
    s_cmp_ge_u32 s33, s37
    s_cselect_b32 s25, 1572864, 0
    s_sub_u32 s33, s33, s25
    s_cmp_eq_u32 s30, 1
    s_cselect_b32 s33, 0x40000000, s33
    s_add_u32 m0, s34, 0
    s_add_u32 s25, s33, 24576
    buffer_load_dwordx4 v7, s[8:11], s33 offen lds
    s_add_u32 m0, s34, 1024
    s_add_u32 s33, s33, 49152
    buffer_load_dwordx4 v7, s[8:11], s25 offen lds
    v_mfma_f32_32x32x16_bf16 v[48:63], v[88:91], v[84:87], v[48:63]
    s_waitcnt vmcnt(6)
    ds_read_b64_tr_b16 v[80:81], v13 offset:10240
    ds_read_b64_tr_b16 v[82:83], v13 offset:10752
    ds_read_b128 v[88:91], v10 offset:8192
    s_waitcnt lgkmcnt(0)
    v_mfma_f32_32x32x16_bf16 v[16:31], v[88:91], v[80:83], v[16:31]
    ds_read_b128 v[92:95], v10 offset:12288
    s_waitcnt lgkmcnt(0)
    v_mfma_f32_32x32x16_bf16 v[32:47], v[92:95], v[80:83], v[32:47]
    ds_read_b64_tr_b16 v[84:85], v8 offset:10240
    ds_read_b64_tr_b16 v[86:87], v8 offset:10752
    s_waitcnt lgkmcnt(0)
    v_mfma_f32_32x32x16_bf16 v[64:79], v[92:95], v[84:87], v[64:79]
    s_add_u32 m0, s34, 2048
    s_add_u32 s25, s33, 24576
    buffer_load_dwordx4 v7, s[8:11], s33 offen lds
    s_add_u32 m0, s34, 3072
    s_add_u32 s33, s33, 49152
    buffer_load_dwordx4 v7, s[8:11], s25 offen lds
    v_mfma_f32_32x32x16_bf16 v[48:63], v[88:91], v[84:87], v[48:63]
    s_waitcnt vmcnt(6)
    ds_read_b64_tr_b16 v[80:81], v13 offset:12288
    ds_read_b64_tr_b16 v[82:83], v13 offset:12800
    ds_read_b128 v[88:91], v11 offset:8192
    s_waitcnt lgkmcnt(0)
    v_mfma_f32_32x32x16_bf16 v[16:31], v[88:91], v[80:83], v[16:31]
    ds_read_b128 v[92:95], v11 offset:12288
    s_waitcnt lgkmcnt(0)
    v_mfma_f32_32x32x16_bf16 v[32:47], v[92:95], v[80:83], v[32:47]
    ds_read_b64_tr_b16 v[84:85], v8 offset:12288
    ds_read_b64_tr_b16 v[86:87], v8 offset:12800
    s_waitcnt lgkmcnt(0)
    v_mfma_f32_32x32x16_bf16 v[64:79], v[92:95], v[84:87], v[64:79]
    s_add_u32 m0, s34, 4096
    s_add_u32 s25, s33, 24576
    buffer_load_dwordx4 v7, s[8:11], s33 offen lds
    s_add_u32 m0, s34, 5120
    s_add_u32 s33, s33, 49152
    buffer_load_dwordx4 v7, s[8:11], s25 offen lds
    v_mfma_f32_32x32x16_bf16 v[48:63], v[88:91], v[84:87], v[48:63]
    s_waitcnt vmcnt(6)
    ds_read_b64_tr_b16 v[80:81], v13 offset:14336
    ds_read_b64_tr_b16 v[82:83], v13 offset:14848
    ds_read_b128 v[88:91], v12 offset:8192
    s_waitcnt lgkmcnt(0)
    v_mfma_f32_32x32x16_bf16 v[16:31], v[88:91], v[80:83], v[16:31]
    ds_read_b128 v[92:95], v12 offset:12288
    s_waitcnt lgkmcnt(0)
    v_mfma_f32_32x32x16_bf16 v[32:47], v[92:95], v[80:83], v[32:47]
    ds_read_b64_tr_b16 v[84:85], v8 offset:14336
    ds_read_b64_tr_b16 v[86:87], v8 offset:14848
    s_waitcnt lgkmcnt(0)
    v_mfma_f32_32x32x16_bf16 v[64:79], v[92:95], v[84:87], v[64:79]
    s_add_u32 m0, s34, 6144
    s_add_u32 s25, s33, 24576
    buffer_load_dwordx4 v7, s[8:11], s33 offen lds
    s_add_u32 m0, s34, 7168
    s_add_u32 s33, s33, 49152
    buffer_load_dwordx4 v7, s[8:11], s25 offen lds
    v_mfma_f32_32x32x16_bf16 v[48:63], v[88:91], v[84:87], v[48:63]
    v_add_u32 v9, 16384, v9
    v_and_b32 v9, 0xffff, v9
    v_add_u32 v10, 16384, v10
    v_and_b32 v10, 0xffff, v10
    v_add_u32 v11, 16384, v11
    v_and_b32 v11, 0xffff, v11
    v_add_u32 v12, 16384, v12
    v_and_b32 v12, 0xffff, v12
    s_sub_u32 s30, s30, 1
    s_cmp_lg_u32 s30, 0
    s_cbranch_scc1 L_p3vl
    s_lshl_b32 s29, s17, 8
    s_add_u32 s29, s29, s32
    s_mul_i32 s29, s29, 2176
    s_add_u32 s29, s29, 0x100000
    s_mov_b32 s26, 139264
    v_lshrrev_b32 v4, 4, v1
    v_mul_lo_u32 v4, v4, s26
    v_bfe_u32 v5, v1, 3, 1
    v_mul_u32_u24 v5, 2176, v5
    v_add_u32 v4, v4, v5
    v_and_b32 v5, 7, v1
    v_lshl_add_u32 v6, v5, 4, v4
    v_mov_b32 v120, 0x3f803f80
    v_mov_b32 v121, 0x3f803f80
    v_mov_b32 v122, 0x3f803f80
    v_mov_b32 v123, 0x3f803f80
    v_bfe_u32 v4, v1, 4, 1
    v_mul_lo_u32 v4, v4, s26
    v_lshrrev_b32 v5, 5, v1
    v_lshl_add_u32 v4, v5, 8, v4
    v_and_b32 v5, 15, v1
    v_lshl_add_u32 v4, v5, 4, v4
    s_waitcnt lgkmcnt(0)
    buffer_store_dwordx4 v[120:123], v6, s[12:15], s29 offen offset:2048 sc1
    v_cvt_pk_bf16_f32 v80, v16, v17
    v_cvt_pk_bf16_f32 v81, v18, v19
    v_cvt_pk_bf16_f32 v82, v20, v21
    v_cvt_pk_bf16_f32 v83, v22, v23
    s_nop 1
    v_permlane32_swap_b32 v80, v82
    v_permlane32_swap_b32 v81, v83
    buffer_store_dwordx4 v[80:83], v4, s[12:15], s29 offen offset:1024 sc1
    v_cvt_pk_bf16_f32 v84, v24, v25
    v_cvt_pk_bf16_f32 v85, v26, v27
    v_cvt_pk_bf16_f32 v86, v28, v29
    v_cvt_pk_bf16_f32 v87, v30, v31
    s_nop 1
    v_permlane32_swap_b32 v84, v86
    v_permlane32_swap_b32 v85, v87
    buffer_store_dwordx4 v[84:87], v4, s[12:15], s29 offen offset:1536 sc1
    v_cvt_pk_bf16_f32 v88, v32, v33
    v_cvt_pk_bf16_f32 v89, v34, v35
    v_cvt_pk_bf16_f32 v90, v36, v37
    v_cvt_pk_bf16_f32 v91, v38, v39
    s_nop 1
    v_permlane32_swap_b32 v88, v90
    v_permlane32_swap_b32 v89, v91
    buffer_store_dwordx4 v[88:91], v4, s[12:15], s29 offen offset:3200 sc1
    v_cvt_pk_bf16_f32 v92, v40, v41
    v_cvt_pk_bf16_f32 v93, v42, v43
    v_cvt_pk_bf16_f32 v94, v44, v45
    v_cvt_pk_bf16_f32 v95, v46, v47
    s_nop 1
    v_permlane32_swap_b32 v92, v94
    v_permlane32_swap_b32 v93, v95
    buffer_store_dwordx4 v[92:95], v4, s[12:15], s29 offen offset:3712 sc1
    s_add_u32 s29, s29, 278528
    v_cvt_pk_bf16_f32 v96, v48, v49
    v_cvt_pk_bf16_f32 v97, v50, v51
    v_cvt_pk_bf16_f32 v98, v52, v53
    v_cvt_pk_bf16_f32 v99, v54, v55
    s_nop 1
    v_permlane32_swap_b32 v96, v98
    v_permlane32_swap_b32 v97, v99
    buffer_store_dwordx4 v[96:99], v4, s[12:15], s29 offen offset:1024 sc1
    v_cvt_pk_bf16_f32 v100, v56, v57
    v_cvt_pk_bf16_f32 v101, v58, v59
    v_cvt_pk_bf16_f32 v102, v60, v61
    v_cvt_pk_bf16_f32 v103, v62, v63
    s_nop 1
    v_permlane32_swap_b32 v100, v102
    v_permlane32_swap_b32 v101, v103
    buffer_store_dwordx4 v[100:103], v4, s[12:15], s29 offen offset:1536 sc1
    v_cvt_pk_bf16_f32 v104, v64, v65
    v_cvt_pk_bf16_f32 v105, v66, v67
    v_cvt_pk_bf16_f32 v106, v68, v69
    v_cvt_pk_bf16_f32 v107, v70, v71
    s_nop 1
    v_permlane32_swap_b32 v104, v106
    v_permlane32_swap_b32 v105, v107
    buffer_store_dwordx4 v[104:107], v4, s[12:15], s29 offen offset:3200 sc1
    v_cvt_pk_bf16_f32 v108, v72, v73
    v_cvt_pk_bf16_f32 v109, v74, v75
    v_cvt_pk_bf16_f32 v110, v76, v77
    v_cvt_pk_bf16_f32 v111, v78, v79
    s_nop 1
    v_permlane32_swap_b32 v108, v110
    v_permlane32_swap_b32 v109, v111
    buffer_store_dwordx4 v[108:111], v4, s[12:15], s29 offen offset:3712 sc1
L_p3pub:
    s_waitcnt vmcnt(0)
    v_mov_b32 v4, 156672
    v_mov_b32 v5, 1
    s_mov_b64 exec, 1
    ds_add_rtn_u32 v5, v4, v5
    s_waitcnt lgkmcnt(0)
    s_mov_b64 exec, -1
    v_readfirstlane_b32 s24, v5
    s_nop 1
    s_cmp_lg_u32 s24, 1
    s_cbranch_scc1 L_p3done
    s_lshl_b32 s26, s17, 5
    s_add_u32 s26, s26, s18
    s_lshl_b32 s26, s26, 5
    s_add_u32 s26, s26, 0x41000
    v_mov_b32 v4, s19
    v_mov_b32 v5, 0
    s_mov_b64 exec, 1
    buffer_store_dword v4, v5, s[12:15], s26 offen sc1
    s_mov_b64 exec, -1
    s_branch L_p3done
L_b_gwave:
    v_bfe_u32 v6, v1, 1, 4
    v_min_u32 v6, 6, v6
    v_add_u32 v6, s18, v6
    v_and_b32 v6, 31, v6
    v_and_b32 v4, 32, v1
    v_add_u32 v6, v6, v4
    v_and_b32 v4, 1, v6
    v_lshrrev_b32 v6, 1, v6
    v_lshl_add_u32 v6, v6, 2, v4
    v_and_b32 v4, 1, v1
    v_lshl_add_u32 v6, v4, 1, v6
    v_lshlrev_b32 v6, 5, v6
    v_lshrrev_b32 v13, 5, v1
    v_lshlrev_b32 v13, 4, v13
    v_add_u32 v13, 155648, v13
    s_waitcnt vmcnt(0)
    v_mov_b32 v4, 156692
    s_mov_b32 s36, 400000
tw_34:
    ds_read_b32 v5, v4
    s_waitcnt lgkmcnt(0)
    v_readfirstlane_b32 s24, v5
    s_nop 1
    s_cmp_ge_u32 s24, 8
    s_cbranch_scc1 twd_35
    s_sub_u32 s36, s36, 1
    s_cbranch_scc1 twd_35
    s_sleep 1
    s_branch tw_34
twd_35:
    s_mov_b32 s30, 2
L_gloop0:
    ds_read_b128 v[80:83], v13 offset:0
    ds_read_b128 v[84:87], v9
    s_waitcnt lgkmcnt(0)
    v_mfma_f32_32x32x16_bf16 v[16:31], v[80:83], v[84:87], v[16:31]
    ds_read_b128 v[88:91], v9 offset:4096
    v_add_u32 v9, 8192, v9
    s_waitcnt lgkmcnt(0)
    v_mfma_f32_32x32x16_bf16 v[32:47], v[80:83], v[88:91], v[32:47]
    ds_read_b128 v[80:83], v13 offset:32
    ds_read_b128 v[84:87], v10
    s_waitcnt lgkmcnt(0)
    v_mfma_f32_32x32x16_bf16 v[16:31], v[80:83], v[84:87], v[16:31]
    ds_read_b128 v[88:91], v10 offset:4096
    v_add_u32 v10, 8192, v10
    s_waitcnt lgkmcnt(0)
    v_mfma_f32_32x32x16_bf16 v[32:47], v[80:83], v[88:91], v[32:47]
    ds_read_b128 v[80:83], v13 offset:64
    ds_read_b128 v[84:87], v11
    s_waitcnt lgkmcnt(0)
    v_mfma_f32_32x32x16_bf16 v[16:31], v[80:83], v[84:87], v[16:31]
    ds_read_b128 v[88:91], v11 offset:4096
    v_add_u32 v11, 8192, v11
    s_waitcnt lgkmcnt(0)
    v_mfma_f32_32x32x16_bf16 v[32:47], v[80:83], v[88:91], v[32:47]
    ds_read_b128 v[80:83], v13 offset:96
    ds_read_b128 v[84:87], v12
    s_waitcnt lgkmcnt(0)
    v_mfma_f32_32x32x16_bf16 v[16:31], v[80:83], v[84:87], v[16:31]
    ds_read_b128 v[88:91], v12 offset:4096
    v_add_u32 v12, 8192, v12
    s_waitcnt lgkmcnt(0)
    v_mfma_f32_32x32x16_bf16 v[32:47], v[80:83], v[88:91], v[32:47]
    v_add_u32 v13, 128, v13
    s_sub_u32 s30, s30, 1
    s_cmp_lg_u32 s30, 0
    s_cbranch_scc1 L_gloop0
    s_and_b32 s26, s17, 7
    s_lshl_b32 s26, s26, 12
    s_add_u32 s26, s26, 0x50000
    s_mov_b32 s36, 400000
poll_36:
    buffer_load_dword v5, v6, s[12:15], s26 offen sc1
    s_waitcnt vmcnt(0)
    v_cmp_ne_u32 vcc, s19, v5
    s_nop 1
    s_cbranch_vccz polld_37
    s_mov_b64 exec, vcc
    s_sub_u32 s36, s36, 1
    s_cbranch_scc1 polld_37
    s_branch poll_36
polld_37:
    s_mov_b64 exec, -1
    s_waitcnt lgkmcnt(0)
    v_mov_b32 v4, 156716
    v_mov_b32 v5, 1
    s_mov_b64 exec, 1
    ds_add_u32 v4, v5
    s_mov_b64 exec, -1
    v_lshlrev_b32 v4, 5, v1
    s_mov_b32 s36, 400000
poll_38:
    buffer_load_dword v5, v4, s[12:15], s26 offen sc1
    buffer_load_dword v6, v4, s[12:15], s26 offen offset:2048 sc1
    s_waitcnt vmcnt(0)
    v_cmp_ne_u32 vcc, s19, v5
    v_cmp_ne_u32 s[38:39], s19, v6
    s_nop 1
    s_or_b64 vcc, vcc, s[38:39]
    s_cbranch_vccz polld_39
    s_mov_b64 exec, vcc
    s_sub_u32 s36, s36, 1
    s_cbranch_scc1 polld_39
    s_sleep 4
    s_branch poll_38
polld_39:
    s_mov_b64 exec, -1
    v_mov_b32 v4, 156708
    v_mov_b32 v5, 1
    s_mov_b64 exec, 1
    ds_add_u32 v4, v5
    s_mov_b64 exec, -1
    s_mov_b32 s30, 6
L_gloop:
    ds_read_b128 v[80:83], v13 offset:0
    ds_read_b128 v[84:87], v9
    s_waitcnt lgkmcnt(0)
    v_mfma_f32_32x32x16_bf16 v[16:31], v[80:83], v[84:87], v[16:31]
    ds_read_b128 v[88:91], v9 offset:4096
    v_add_u32 v9, 8192, v9
    s_waitcnt lgkmcnt(0)
    v_mfma_f32_32x32x16_bf16 v[32:47], v[80:83], v[88:91], v[32:47]
    ds_read_b128 v[80:83], v13 offset:32
    ds_read_b128 v[84:87], v10
    s_waitcnt lgkmcnt(0)
    v_mfma_f32_32x32x16_bf16 v[16:31], v[80:83], v[84:87], v[16:31]
    ds_read_b128 v[88:91], v10 offset:4096
    v_add_u32 v10, 8192, v10
    s_waitcnt lgkmcnt(0)
    v_mfma_f32_32x32x16_bf16 v[32:47], v[80:83], v[88:91], v[32:47]
    ds_read_b128 v[80:83], v13 offset:64
    ds_read_b128 v[84:87], v11
    s_waitcnt lgkmcnt(0)
    v_mfma_f32_32x32x16_bf16 v[16:31], v[80:83], v[84:87], v[16:31]
    ds_read_b128 v[88:91], v11 offset:4096
    v_add_u32 v11, 8192, v11
    s_waitcnt lgkmcnt(0)
    v_mfma_f32_32x32x16_bf16 v[32:47], v[80:83], v[88:91], v[32:47]
    ds_read_b128 v[80:83], v13 offset:96
    ds_read_b128 v[84:87], v12
    s_waitcnt lgkmcnt(0)
    v_mfma_f32_32x32x16_bf16 v[16:31], v[80:83], v[84:87], v[16:31]
    ds_read_b128 v[88:91], v12 offset:4096
    v_add_u32 v12, 8192, v12
    s_waitcnt lgkmcnt(0)
    v_mfma_f32_32x32x16_bf16 v[32:47], v[80:83], v[88:91], v[32:47]
    v_add_u32 v13, 128, v13
    s_sub_u32 s30, s30, 1
    s_cmp_lg_u32 s30, 0
    s_cbranch_scc1 L_gloop
    s_mov_b32 s38, 0
    s_mov_b32 s39, -1
    s_nop 5
    v_cndmask_b32_e64 v15, v16, v32, s[38:39]
    v_mul_f32 v15, 0xbfb8aa3b, v15
    v_exp_f32 v15, v15
    v_lshlrev_b32 v4, 2, v1
    v_add_f32 v15, 1.0, v15
    v_rcp_f32 v15, v15
    v_add_u32 v4, 156928, v4
    ds_write_b32 v4, v15
    s_waitcnt lgkmcnt(0)
L_p3done:
    v_mov_b32 v4, 156676
    v_mov_b32 v5, 1
    s_mov_b64 exec, 1
    ds_add_u32 v4, v5
    s_mov_b64 exec, -1
    s_lshl_b32 s29, s31, 6
    s_add_u32 s29, s29, s32
    s_mul_i32 s29, s29, 2176
    s_add_u32 s29, s29, 0x100000
    s_mov_b32 s8, s58
    s_and_b32 s9, s59, 0xffff
    s_mov_b32 s10, 0x80000
    s_mov_b32 s11, 0x00020000
    s_mov_b32 s20, s52
    s_and_b32 s21, s53, 0xffff
    s_mov_b32 s22, 0x80000
    s_mov_b32 s23, 0x00020000
    v_lshrrev_b32 v4, 3, v1
    v_lshlrev_b32 v4, 10, v4
    v_lshrrev_b32 v5, 2, v1
    v_and_b32 v5, 4, v5
    v_xor_b32 v5, v5, v1
    v_and_b32 v5, 7, v5
    v_lshl_add_u32 v11, v5, 4, v4
    s_lshl_b32 s37, s28, 14
    s_lshl_b32 s54, s28, 17
    s_lshl_b32 s24, s17, 7
    s_add_u32 s54, s54, s24
    s_mov_b32 s55, 0
    s_and_b32 s56, s18, 7
    s_lshl_b32 s56, s56, 1
    s_lshl_b32 s25, s28, 10
    s_add_u32 s25, s25, 147456
    v_add_u32 v7, s25, v2
    s_and_b32 s25, s28, 1
    s_lshl_b32 s25, s25, 7
    s_add_u32 s25, s25, 156928
    v_and_b32 v9, 31, v1
    v_lshl_add_u32 v9, v9, 2, s25
    v_mov_b32 v4, 156676
    s_mov_b32 s36, 400000
tw_40:
    ds_read_b32 v5, v4
    s_waitcnt lgkmcnt(0)
    v_readfirstlane_b32 s24, v5
    s_nop 1
    s_cmp_ge_u32 s24, 4
    s_cbranch_scc1 twd_41
    s_sub_u32 s36, s36, 1
    s_cbranch_scc1 twd_41
    s_sleep 2
    s_branch tw_40
twd_41:
    s_mov_b32 s55, 16
L_wB:
    s_lshl_b32 s57, s56, 10
    s_add_u32 s57, s57, s37
    s_add_u32 m0, s57, 0
    s_lshl_b32 s57, s56, 13
    s_add_u32 s57, s57, s54
    buffer_load_dwordx4 v11, s[8:11], s57 offen lds
    s_add_u32 s56, s56, 1
    s_and_b32 s56, s56, 15
    s_sub_u32 s55, s55, 1
    s_waitcnt vmcnt(5)
    s_cmp_lg_u32 s55, 0
    s_cbranch_scc1 L_wB
    s_cmp_lg_u32 s28, 3
    s_cbranch_scc1 L_b_nokvb
    v_min_u32 v6, 4, v1
    v_sub_u32 v6, s18, v6
    v_max_i32 v6, 0, v6
    v_lshlrev_b32 v6, 5, v6
    s_lshl_b32 s26, s17, 10
    s_add_u32 s26, s26, 0x41000
    s_mov_b32 s36, 400000
poll_42:
    buffer_load_dword v5, v6, s[12:15], s26 offen sc1
    s_waitcnt vmcnt(0)
    v_cmp_ne_u32 vcc, s19, v5
    s_nop 1
    s_cbranch_vccz polld_43
    s_mov_b64 exec, vcc
    s_sub_u32 s36, s36, 1
    s_cbranch_scc1 polld_43
    s_sleep 2
    s_branch poll_42
polld_43:
    s_mov_b64 exec, -1
    v_mov_b32 v4, 156712
    v_mov_b32 v5, 1
    s_mov_b64 exec, 1
    ds_add_u32 v4, v5
    s_mov_b64 exec, -1
L_b_nokvb:
    v_mov_b32 v4, 156712
    s_mov_b32 s36, 400000
tw_44:
    ds_read_b32 v5, v4
    s_waitcnt lgkmcnt(0)
    v_readfirstlane_b32 s24, v5
    s_nop 1
    s_cmp_ge_u32 s24, 1
    s_cbranch_scc1 twd_45
    s_sub_u32 s36, s36, 1
    s_cbranch_scc1 twd_45
    s_sleep 2
    s_branch tw_44
twd_45:
    ds_read_b128 v[96:99], v7
    ds_read_b128 v[100:103], v7 offset:4096
    ds_read_b32 v15, v9
    s_add_u32 s33, s29, 2176
    s_add_u32 s34, s32, 1
    buffer_load_dwordx4 v[136:139], v2, s[12:15], s33 offen sc1
    buffer_load_dwordx4 v[140:143], v3, s[12:15], s33 offen sc1
    buffer_load_dwordx4 v[144:147], v0, s[12:15], s33 offen sc1
    s_sub_u32 s33, s33, 2176
    buffer_load_dwordx4 v[148:151], v2, s[12:15], s33 offen sc1
    buffer_load_dwordx4 v[152:155], v3, s[12:15], s33 offen sc1
    buffer_load_dwordx4 v[156:159], v0, s[12:15], s33 offen sc1
    s_sub_u32 s33, s33, 2176
    s_cmp_ge_u32 s34, 2
    s_cselect_b32 s24, s33, 0x40000000
    buffer_load_dwordx4 v[160:163], v2, s[12:15], s24 offen sc1
    buffer_load_dwordx4 v[164:167], v3, s[12:15], s24 offen sc1
    buffer_load_dwordx4 v[168:171], v0, s[12:15], s24 offen sc1
    s_sub_u32 s33, s33, 2176
    v_mov_b32 v10, 0xdddddddd
    v_mov_b32 v7, 0xfe967699
    s_mov_b32 s40, 0x0
    s_mov_b32 s41, 0xf
    v_cndmask_b32_e64 v16, 0, v7, s[40:41]
    s_mov_b32 s42, 0x1
    s_mov_b32 s43, 0x1f
    v_cndmask_b32_e64 v17, 0, v7, s[42:43]
    s_mov_b32 s40, 0x3
    s_mov_b32 s41, 0x3f
    v_cndmask_b32_e64 v18, 0, v7, s[40:41]
    s_mov_b32 s42, 0x7
    s_mov_b32 s43, 0x7f
    v_cndmask_b32_e64 v19, 0, v7, s[42:43]
    s_mov_b32 s40, 0xff
    s_mov_b32 s41, 0xfff
    v_cndmask_b32_e64 v20, 0, v7, s[40:41]
    s_mov_b32 s42, 0x1ff
    s_mov_b32 s43, 0x1fff
    v_cndmask_b32_e64 v21, 0, v7, s[42:43]
    s_mov_b32 s40, 0x3ff
    s_mov_b32 s41, 0x3fff
    v_cndmask_b32_e64 v22, 0, v7, s[40:41]
    s_mov_b32 s42, 0x7ff
    s_mov_b32 s43, 0x7fff
    v_cndmask_b32_e64 v23, 0, v7, s[42:43]
    s_mov_b32 s40, 0xffff
    s_mov_b32 s41, 0xfffff
    v_cndmask_b32_e64 v24, 0, v7, s[40:41]
    s_mov_b32 s42, 0x1ffff
    s_mov_b32 s43, 0x1fffff
    v_cndmask_b32_e64 v25, 0, v7, s[42:43]
    s_mov_b32 s40, 0x3ffff
    s_mov_b32 s41, 0x3fffff
    v_cndmask_b32_e64 v26, 0, v7, s[40:41]
    s_mov_b32 s42, 0x7ffff
    s_mov_b32 s43, 0x7fffff
    v_cndmask_b32_e64 v27, 0, v7, s[42:43]
    s_mov_b32 s40, 0xffffff
    s_mov_b32 s41, 0xfffffff
    v_cndmask_b32_e64 v28, 0, v7, s[40:41]
    s_mov_b32 s42, 0x1ffffff
    s_mov_b32 s43, 0x1fffffff
    v_cndmask_b32_e64 v29, 0, v7, s[42:43]
    s_mov_b32 s40, 0x3ffffff
    s_mov_b32 s41, 0x3fffffff
    v_cndmask_b32_e64 v30, 0, v7, s[40:41]
    s_mov_b32 s42, 0x7ffffff
    s_mov_b32 s43, 0x7fffffff
    v_cndmask_b32_e64 v31, 0, v7, s[42:43]
    v_pk_mov_b32 v[104:105], 0, 0
    v_pk_mov_b32 v[106:107], 0, 0
    v_pk_mov_b32 v[108:109], 0, 0
    v_pk_mov_b32 v[110:111], 0, 0
    v_pk_mov_b32 v[112:113], 0, 0
    v_pk_mov_b32 v[120:121], 0, 0
    v_pk_mov_b32 v[122:123], 0, 0
    v_pk_mov_b32 v[124:125], 0, 0
    v_pk_mov_b32 v[126:127], 0, 0
    v_pk_mov_b32 v[128:129], 0, 0
    s_waitcnt vmcnt(5) lgkmcnt(0)
    v_mfma_f32_32x32x16_bf16 v[32:47], v[136:139], v[100:103], v[16:31]
    v_mfma_f32_32x32x16_bf16 v[48:63], v[148:151], v[96:99], v[16:31]
    s_nop 7
    s_nop 3
    v_max3_f32 v4, v32, v33, v34
    v_max3_f32 v5, v35, v36, v37
    v_max3_f32 v4, v4, v38, v39
    v_max3_f32 v5, v5, v40, v41
    v_max3_f32 v4, v4, v42, v43
    v_max3_f32 v5, v5, v44, v45
    v_max3_f32 v4, v4, v46, v47
    v_max3_f32 v5, v5, v48, v49
    v_max3_f32 v4, v4, v50, v51
    v_max3_f32 v5, v5, v52, v53
    v_max3_f32 v4, v4, v54, v55
    v_max3_f32 v5, v5, v56, v57
    v_max3_f32 v4, v4, v58, v59
    v_max3_f32 v5, v5, v60, v61
    v_max3_f32 v4, v4, v62, v63
    v_max_f32 v4, v4, v5
    v_mov_b32 v5, v4
    s_nop 1
    v_permlane32_swap_b32 v4, v5
    v_max_f32 v4, v4, v5
    v_sub_f32 v16, 0, v4
    v_sub_f32 v17, 0, v4
    v_pk_add_f32 v[32:33], v[32:33], v[16:17]
    v_pk_add_f32 v[34:35], v[34:35], v[16:17]
    v_pk_add_f32 v[36:37], v[36:37], v[16:17]
    v_pk_add_f32 v[38:39], v[38:39], v[16:17]
    v_pk_add_f32 v[40:41], v[40:41], v[16:17]
    v_pk_add_f32 v[42:43], v[42:43], v[16:17]
    v_pk_add_f32 v[44:45], v[44:45], v[16:17]
    v_pk_add_f32 v[46:47], v[46:47], v[16:17]
    v_pk_add_f32 v[48:49], v[48:49], v[16:17]
    v_pk_add_f32 v[50:51], v[50:51], v[16:17]
    v_pk_add_f32 v[52:53], v[52:53], v[16:17]
    v_pk_add_f32 v[54:55], v[54:55], v[16:17]
    v_pk_add_f32 v[56:57], v[56:57], v[16:17]
    v_pk_add_f32 v[58:59], v[58:59], v[16:17]
    v_pk_add_f32 v[60:61], v[60:61], v[16:17]
    v_pk_add_f32 v[62:63], v[62:63], v[16:17]
    v_pk_mov_b32 v[18:19], v[16:17], v[16:17] op_sel:[0,1]
    v_pk_mov_b32 v[20:21], v[16:17], v[16:17] op_sel:[0,1]
    v_pk_mov_b32 v[22:23], v[16:17], v[16:17] op_sel:[0,1]
    v_pk_mov_b32 v[24:25], v[16:17], v[16:17] op_sel:[0,1]
    v_pk_mov_b32 v[26:27], v[16:17], v[16:17] op_sel:[0,1]
    v_pk_mov_b32 v[28:29], v[16:17], v[16:17] op_sel:[0,1]
    v_pk_mov_b32 v[30:31], v[16:17], v[16:17] op_sel:[0,1]
    v_exp_f32 v32, v32
    v_exp_f32 v33, v33
    v_exp_f32 v34, v34
    v_exp_f32 v35, v35
    v_exp_f32 v36, v36
    v_exp_f32 v37, v37
    v_exp_f32 v38, v38
    v_exp_f32 v39, v39
    v_exp_f32 v40, v40
    v_exp_f32 v41, v41
    v_exp_f32 v42, v42
    v_smfmac_f32_32x32x32_bf16 v[120:135], v[140:143], v[32:39], v10
    v_exp_f32 v43, v43
    v_exp_f32 v44, v44
    v_exp_f32 v45, v45
    v_exp_f32 v46, v46
    v_exp_f32 v47, v47
    v_exp_f32 v48, v48
    v_exp_f32 v49, v49
    v_smfmac_f32_32x32x32_bf16 v[120:135], v[144:147], v[40:47], v10
    v_exp_f32 v50, v50
    v_exp_f32 v51, v51
    v_exp_f32 v52, v52
    v_mfma_f32_32x32x16_bf16 v[32:47], v[148:151], v[100:103], v[16:31]
    v_exp_f32 v53, v53
    v_exp_f32 v54, v54
    v_exp_f32 v55, v55
    v_exp_f32 v56, v56
    v_exp_f32 v57, v57
    v_exp_f32 v58, v58
    s_waitcnt vmcnt(3)
    v_smfmac_f32_32x32x32_bf16 v[104:119], v[152:155], v[48:55], v10
    s_cmp_ge_u32 s34, 3
    s_cselect_b32 s24, s33, 0x40000000
    buffer_load_dwordx4 v[172:175], v2, s[12:15], s24 offen sc1
    buffer_load_dwordx4 v[176:179], v3, s[12:15], s24 offen sc1
    buffer_load_dwordx4 v[180:183], v0, s[12:15], s24 offen sc1
    s_sub_u32 s33, s33, 2176
    v_exp_f32 v59, v59
    v_exp_f32 v60, v60
    v_exp_f32 v61, v61
    v_exp_f32 v62, v62
    v_exp_f32 v63, v63
    v_exp_f32 v32, v32
    v_exp_f32 v33, v33
    v_smfmac_f32_32x32x32_bf16 v[104:119], v[156:159], v[56:63], v10
    v_exp_f32 v34, v34
    v_exp_f32 v35, v35
    v_exp_f32 v36, v36
    s_waitcnt vmcnt(5)
    v_mfma_f32_32x32x16_bf16 v[48:63], v[160:163], v[96:99], v[16:31]
    v_exp_f32 v37, v37
    v_exp_f32 v38, v38
    v_exp_f32 v39, v39
    v_exp_f32 v40, v40
    v_exp_f32 v41, v41
    v_exp_f32 v42, v42
    v_smfmac_f32_32x32x32_bf16 v[120:135], v[152:155], v[32:39], v10
    s_cmp_eq_u32 s34, 1
    v_exp_f32 v43, v43
    v_exp_f32 v44, v44
    v_exp_f32 v45, v45
    v_exp_f32 v46, v46
    v_exp_f32 v47, v47
    s_cbranch_scc1 L_b_exit1
    v_exp_f32 v48, v48
    v_exp_f32 v49, v49
    v_smfmac_f32_32x32x32_bf16 v[120:135], v[156:159], v[40:47], v10
    v_exp_f32 v50, v50
    v_exp_f32 v51, v51
    v_exp_f32 v52, v52
    v_mfma_f32_32x32x16_bf16 v[32:47], v[160:163], v[100:103], v[16:31]
    v_exp_f32 v53, v53
    v_exp_f32 v54, v54
    v_exp_f32 v55, v55
    v_exp_f32 v56, v56
    v_exp_f32 v57, v57
    v_exp_f32 v58, v58
    s_waitcnt vmcnt(3)
    v_smfmac_f32_32x32x32_bf16 v[104:119], v[164:167], v[48:55], v10
    s_cmp_ge_u32 s34, 4
    s_cselect_b32 s24, s33, 0x40000000
    buffer_load_dwordx4 v[184:187], v2, s[12:15], s24 offen sc1
    buffer_load_dwordx4 v[188:191], v3, s[12:15], s24 offen sc1
    buffer_load_dwordx4 v[192:195], v0, s[12:15], s24 offen sc1
    s_sub_u32 s33, s33, 2176
    v_exp_f32 v59, v59
    v_exp_f32 v60, v60
    v_exp_f32 v61, v61
    v_exp_f32 v62, v62
    v_exp_f32 v63, v63
    v_exp_f32 v32, v32
    v_exp_f32 v33, v33
    v_smfmac_f32_32x32x32_bf16 v[104:119], v[168:171], v[56:63], v10
    v_exp_f32 v34, v34
    v_exp_f32 v35, v35
    v_exp_f32 v36, v36
    s_waitcnt vmcnt(5)
    v_mfma_f32_32x32x16_bf16 v[48:63], v[172:175], v[96:99], v[16:31]
    v_exp_f32 v37, v37
    v_exp_f32 v38, v38
    v_exp_f32 v39, v39
    v_exp_f32 v40, v40
    v_exp_f32 v41, v41
    v_exp_f32 v42, v42
    v_smfmac_f32_32x32x32_bf16 v[120:135], v[164:167], v[32:39], v10
    v_exp_f32 v43, v43
    v_exp_f32 v44, v44
    v_exp_f32 v45, v45
    v_exp_f32 v46, v46
    v_exp_f32 v47, v47
    v_exp_f32 v48, v48
    v_exp_f32 v49, v49
    v_smfmac_f32_32x32x32_bf16 v[120:135], v[168:171], v[40:47], v10
    v_exp_f32 v50, v50
    v_exp_f32 v51, v51
    v_exp_f32 v52, v52
    v_mfma_f32_32x32x16_bf16 v[32:47], v[172:175], v[100:103], v[16:31]
    v_exp_f32 v53, v53
    v_exp_f32 v54, v54
    v_exp_f32 v55, v55
    v_exp_f32 v56, v56
    v_exp_f32 v57, v57
    v_exp_f32 v58, v58
    s_waitcnt vmcnt(3)
    v_smfmac_f32_32x32x32_bf16 v[104:119], v[176:179], v[48:55], v10
    s_cmp_ge_u32 s34, 5
    s_cselect_b32 s24, s33, 0x40000000
    buffer_load_dwordx4 v[196:199], v2, s[12:15], s24 offen sc1
    buffer_load_dwordx4 v[200:203], v3, s[12:15], s24 offen sc1
    buffer_load_dwordx4 v[204:207], v0, s[12:15], s24 offen sc1
    s_sub_u32 s33, s33, 2176
    v_exp_f32 v59, v59
    v_exp_f32 v60, v60
    v_exp_f32 v61, v61
    v_exp_f32 v62, v62
    v_exp_f32 v63, v63
    v_exp_f32 v32, v32
    v_exp_f32 v33, v33
    v_smfmac_f32_32x32x32_bf16 v[104:119], v[180:183], v[56:63], v10
    v_exp_f32 v34, v34
    v_exp_f32 v35, v35
    v_exp_f32 v36, v36
    s_waitcnt vmcnt(5)
    v_mfma_f32_32x32x16_bf16 v[48:63], v[184:187], v[96:99], v[16:31]
    v_exp_f32 v37, v37
    v_exp_f32 v38, v38
    v_exp_f32 v39, v39
    v_exp_f32 v40, v40
    v_exp_f32 v41, v41
    v_exp_f32 v42, v42
    v_smfmac_f32_32x32x32_bf16 v[120:135], v[176:179], v[32:39], v10
    s_cmp_eq_u32 s34, 3
    v_exp_f32 v43, v43
    v_exp_f32 v44, v44
    v_exp_f32 v45, v45
    v_exp_f32 v46, v46
    v_exp_f32 v47, v47
    s_cbranch_scc1 L_b_exit3
    s_mov_b32 s40, 0x0
    s_mov_b32 s41, 0xf
    v_cndmask_b32_e64 v136, v7, v16, s[40:41]
    s_mov_b32 s42, 0x1
    s_mov_b32 s43, 0x1f
    v_cndmask_b32_e64 v137, v7, v16, s[42:43]
    s_mov_b32 s40, 0x3
    s_mov_b32 s41, 0x3f
    v_cndmask_b32_e64 v138, v7, v16, s[40:41]
    s_mov_b32 s42, 0x7
    s_mov_b32 s43, 0x7f
    v_cndmask_b32_e64 v139, v7, v16, s[42:43]
    s_mov_b32 s40, 0xff
    s_mov_b32 s41, 0xfff
    v_cndmask_b32_e64 v140, v7, v16, s[40:41]
    s_mov_b32 s42, 0x1ff
    s_mov_b32 s43, 0x1fff
    v_cndmask_b32_e64 v141, v7, v16, s[42:43]
    s_mov_b32 s40, 0x3ff
    s_mov_b32 s41, 0x3fff
    v_cndmask_b32_e64 v142, v7, v16, s[40:41]
    s_mov_b32 s42, 0x7ff
    s_mov_b32 s43, 0x7fff
    v_cndmask_b32_e64 v143, v7, v16, s[42:43]
    s_mov_b32 s40, 0xffff
    s_mov_b32 s41, 0xfffff
    v_cndmask_b32_e64 v144, v7, v16, s[40:41]
    s_mov_b32 s42, 0x1ffff
    s_mov_b32 s43, 0x1fffff
    v_cndmask_b32_e64 v145, v7, v16, s[42:43]
    s_mov_b32 s40, 0x3ffff
    s_mov_b32 s41, 0x3fffff
    v_cndmask_b32_e64 v146, v7, v16, s[40:41]
    s_mov_b32 s42, 0x7ffff
    s_mov_b32 s43, 0x7fffff
    v_cndmask_b32_e64 v147, v7, v16, s[42:43]
    s_mov_b32 s40, 0xffffff
    s_mov_b32 s41, 0xfffffff
    v_cndmask_b32_e64 v148, v7, v16, s[40:41]
    s_mov_b32 s42, 0x1ffffff
    s_mov_b32 s43, 0x1fffffff
    v_cndmask_b32_e64 v149, v7, v16, s[42:43]
    s_mov_b32 s40, 0x3ffffff
    s_mov_b32 s41, 0x3fffffff
    v_cndmask_b32_e64 v150, v7, v16, s[40:41]
    s_mov_b32 s42, 0x7ffffff
    s_mov_b32 s43, 0x7fffffff
    v_cndmask_b32_e64 v151, v7, v16, s[42:43]
    v_exp_f32 v48, v48
    v_exp_f32 v49, v49
    v_smfmac_f32_32x32x32_bf16 v[120:135], v[180:183], v[40:47], v10
    v_exp_f32 v50, v50
    v_exp_f32 v51, v51
    v_exp_f32 v52, v52
    v_mfma_f32_32x32x16_bf16 v[32:47], v[184:187], v[100:103], v[16:31]
    v_exp_f32 v53, v53
    v_exp_f32 v54, v54
    v_exp_f32 v55, v55
    v_exp_f32 v56, v56
    v_exp_f32 v57, v57
    v_exp_f32 v58, v58
    s_waitcnt vmcnt(3)
    v_smfmac_f32_32x32x32_bf16 v[104:119], v[188:191], v[48:55], v10
    s_cmp_ge_u32 s34, 6
    s_cselect_b32 s24, s33, 0x40000000
    buffer_load_dwordx4 v[208:211], v2, s[12:15], s24 offen sc1
    buffer_load_dwordx4 v[212:215], v3, s[12:15], s24 offen sc1
    buffer_load_dwordx4 v[216:219], v0, s[12:15], s24 offen sc1
    s_sub_u32 s33, s33, 2176
    v_exp_f32 v59, v59
    v_exp_f32 v60, v60
    v_exp_f32 v61, v61
    v_exp_f32 v62, v62
    v_exp_f32 v63, v63
    v_exp_f32 v32, v32
    v_exp_f32 v33, v33
    v_smfmac_f32_32x32x32_bf16 v[104:119], v[192:195], v[56:63], v10
    v_exp_f32 v34, v34
    v_exp_f32 v35, v35
    v_exp_f32 v36, v36
    s_waitcnt vmcnt(5)
    v_mfma_f32_32x32x16_bf16 v[48:63], v[196:199], v[96:99], v[16:31]
    v_exp_f32 v37, v37
    v_exp_f32 v38, v38
    v_exp_f32 v39, v39
    v_exp_f32 v40, v40
    v_exp_f32 v41, v41
    v_exp_f32 v42, v42
    v_smfmac_f32_32x32x32_bf16 v[120:135], v[188:191], v[32:39], v10
    v_exp_f32 v43, v43
    v_exp_f32 v44, v44
    v_exp_f32 v45, v45
    v_exp_f32 v46, v46
    v_exp_f32 v47, v47
    v_exp_f32 v48, v48
    v_exp_f32 v49, v49
    v_smfmac_f32_32x32x32_bf16 v[120:135], v[192:195], v[40:47], v10
    v_exp_f32 v50, v50
    v_exp_f32 v51, v51
    v_exp_f32 v52, v52
    v_mfma_f32_32x32x16_bf16 v[32:47], v[196:199], v[100:103], v[16:31]
    v_exp_f32 v53, v53
    v_exp_f32 v54, v54
    v_exp_f32 v55, v55
    v_exp_f32 v56, v56
    v_exp_f32 v57, v57
    v_exp_f32 v58, v58
    s_waitcnt vmcnt(3)
    v_smfmac_f32_32x32x32_bf16 v[104:119], v[200:203], v[48:55], v10
    s_cmp_ge_u32 s34, 7
    s_cselect_b32 s24, s33, 0x40000000
    buffer_load_dwordx4 v[220:223], v2, s[12:15], s24 offen sc1
    buffer_load_dwordx4 v[224:227], v3, s[12:15], s24 offen sc1
    buffer_load_dwordx4 v[228:231], v0, s[12:15], s24 offen sc1
    s_sub_u32 s33, s33, 2176
    v_exp_f32 v59, v59
    v_exp_f32 v60, v60
    v_exp_f32 v61, v61
    v_exp_f32 v62, v62
    v_exp_f32 v63, v63
    v_exp_f32 v32, v32
    v_exp_f32 v33, v33
    v_smfmac_f32_32x32x32_bf16 v[104:119], v[204:207], v[56:63], v10
    v_exp_f32 v34, v34
    v_exp_f32 v35, v35
    v_exp_f32 v36, v36
    s_waitcnt vmcnt(5)
    v_mfma_f32_32x32x16_bf16 v[48:63], v[208:211], v[96:99], v[16:31]
    v_exp_f32 v37, v37
    v_exp_f32 v38, v38
    v_exp_f32 v39, v39
    v_exp_f32 v40, v40
    v_exp_f32 v41, v41
    v_exp_f32 v42, v42
    v_smfmac_f32_32x32x32_bf16 v[120:135], v[200:203], v[32:39], v10
    s_cmp_eq_u32 s34, 5
    v_exp_f32 v43, v43
    v_exp_f32 v44, v44
    v_exp_f32 v45, v45
    v_exp_f32 v46, v46
    v_exp_f32 v47, v47
    s_cbranch_scc1 L_b_exit5
    v_exp_f32 v48, v48
    v_exp_f32 v49, v49
    v_smfmac_f32_32x32x32_bf16 v[120:135], v[204:207], v[40:47], v10
    v_exp_f32 v50, v50
    v_exp_f32 v51, v51
    v_exp_f32 v52, v52
    v_mfma_f32_32x32x16_bf16 v[32:47], v[208:211], v[100:103], v[16:31]
    v_exp_f32 v53, v53
    v_exp_f32 v54, v54
    v_exp_f32 v55, v55
    v_exp_f32 v56, v56
    v_exp_f32 v57, v57
    v_exp_f32 v58, v58
    s_waitcnt vmcnt(3)
    v_smfmac_f32_32x32x32_bf16 v[104:119], v[212:215], v[48:55], v10
    s_cmp_ge_u32 s34, 8
    s_cselect_b32 s24, s33, 0x40000000
    buffer_load_dwordx4 v[232:235], v2, s[12:15], s24 offen sc1
    buffer_load_dwordx4 v[236:239], v3, s[12:15], s24 offen sc1
    buffer_load_dwordx4 v[240:243], v0, s[12:15], s24 offen sc1
    s_sub_u32 s33, s33, 2176
    v_exp_f32 v59, v59
    v_exp_f32 v60, v60
    v_exp_f32 v61, v61
    v_exp_f32 v62, v62
    v_exp_f32 v63, v63
    v_exp_f32 v32, v32
    v_exp_f32 v33, v33
    v_smfmac_f32_32x32x32_bf16 v[104:119], v[216:219], v[56:63], v10
    v_exp_f32 v34, v34
    v_exp_f32 v35, v35
    v_exp_f32 v36, v36
    s_waitcnt vmcnt(5)
    v_mfma_f32_32x32x16_bf16 v[48:63], v[220:223], v[96:99], v[16:31]
    v_exp_f32 v37, v37
    v_exp_f32 v38, v38
    v_exp_f32 v39, v39
    v_exp_f32 v40, v40
    v_exp_f32 v41, v41
    v_exp_f32 v42, v42
    v_smfmac_f32_32x32x32_bf16 v[120:135], v[212:215], v[32:39], v10
    v_exp_f32 v43, v43
    v_exp_f32 v44, v44
    v_exp_f32 v45, v45
    v_exp_f32 v46, v46
    v_exp_f32 v47, v47
    v_exp_f32 v48, v48
    v_exp_f32 v49, v49
    v_smfmac_f32_32x32x32_bf16 v[120:135], v[216:219], v[40:47], v10
    v_exp_f32 v50, v50
    v_exp_f32 v51, v51
    v_exp_f32 v52, v52
    v_mfma_f32_32x32x16_bf16 v[32:47], v[220:223], v[100:103], v[16:31]
    v_exp_f32 v53, v53
    v_exp_f32 v54, v54
    v_exp_f32 v55, v55
    v_exp_f32 v56, v56
    v_exp_f32 v57, v57
    v_exp_f32 v58, v58
    s_waitcnt vmcnt(3)
    v_smfmac_f32_32x32x32_bf16 v[104:119], v[224:227], v[48:55], v10
    s_cmp_ge_u32 s34, 9
    s_cselect_b32 s24, s33, 0x40000000
    buffer_load_dwordx4 v[244:247], v2, s[12:15], s24 offen sc1
    buffer_load_dwordx4 v[248:251], v3, s[12:15], s24 offen sc1
    buffer_load_dwordx4 v[252:255], v0, s[12:15], s24 offen sc1
    v_exp_f32 v59, v59
    v_exp_f32 v60, v60
    v_exp_f32 v61, v61
    v_exp_f32 v62, v62
    v_exp_f32 v63, v63
    v_exp_f32 v32, v32
    v_exp_f32 v33, v33
    v_smfmac_f32_32x32x32_bf16 v[104:119], v[228:231], v[56:63], v10
    v_exp_f32 v34, v34
    v_exp_f32 v35, v35
    v_exp_f32 v36, v36
    s_waitcnt vmcnt(5)
    v_mfma_f32_32x32x16_bf16 v[48:63], v[232:235], v[96:99], v[16:31]
    v_exp_f32 v37, v37
    v_exp_f32 v38, v38
    v_exp_f32 v39, v39
    v_exp_f32 v40, v40
    v_exp_f32 v41, v41
    v_exp_f32 v42, v42
    v_smfmac_f32_32x32x32_bf16 v[120:135], v[224:227], v[32:39], v10
    s_cmp_eq_u32 s34, 7
    v_exp_f32 v43, v43
    v_exp_f32 v44, v44
    v_exp_f32 v45, v45
    v_exp_f32 v46, v46
    v_exp_f32 v47, v47
    s_cbranch_scc1 L_b_exit7
    v_exp_f32 v48, v48
    v_exp_f32 v49, v49
    v_smfmac_f32_32x32x32_bf16 v[120:135], v[228:231], v[40:47], v10
    v_exp_f32 v50, v50
    v_exp_f32 v51, v51
    v_exp_f32 v52, v52
    v_mfma_f32_32x32x16_bf16 v[32:47], v[232:235], v[100:103], v[136:151]
    v_exp_f32 v53, v53
    v_exp_f32 v54, v54
    v_exp_f32 v55, v55
    v_exp_f32 v56, v56
    v_exp_f32 v57, v57
    v_exp_f32 v58, v58
    s_waitcnt vmcnt(3)
    v_smfmac_f32_32x32x32_bf16 v[104:119], v[236:239], v[48:55], v10
    v_exp_f32 v59, v59
    v_exp_f32 v60, v60
    v_exp_f32 v61, v61
    v_exp_f32 v62, v62
    v_exp_f32 v63, v63
    v_exp_f32 v32, v32
    v_exp_f32 v33, v33
    v_smfmac_f32_32x32x32_bf16 v[104:119], v[240:243], v[56:63], v10
    v_exp_f32 v34, v34
    v_exp_f32 v35, v35
    v_exp_f32 v36, v36
    s_waitcnt vmcnt(2)
    v_mfma_f32_32x32x16_bf16 v[48:63], v[244:247], v[96:99], v[136:151]
    v_exp_f32 v37, v37
    v_exp_f32 v38, v38
    v_exp_f32 v39, v39
    v_exp_f32 v40, v40
    v_exp_f32 v41, v41
    v_exp_f32 v42, v42
    v_smfmac_f32_32x32x32_bf16 v[120:135], v[236:239], v[32:39], v10
    v_exp_f32 v43, v43
    v_exp_f32 v44, v44
    v_exp_f32 v45, v45
    v_exp_f32 v46, v46
    v_exp_f32 v47, v47
    v_exp_f32 v48, v48
    v_exp_f32 v49, v49
    v_smfmac_f32_32x32x32_bf16 v[120:135], v[240:243], v[40:47], v10
    v_exp_f32 v50, v50
    v_exp_f32 v51, v51
    v_exp_f32 v52, v52
    v_exp_f32 v53, v53
    v_exp_f32 v54, v54
    v_exp_f32 v55, v55
    v_exp_f32 v56, v56
    v_exp_f32 v57, v57
    v_exp_f32 v58, v58
    s_waitcnt vmcnt(0)
    v_smfmac_f32_32x32x32_bf16 v[104:119], v[248:251], v[48:55], v10
    v_exp_f32 v59, v59
    v_exp_f32 v60, v60
    v_exp_f32 v61, v61
    v_exp_f32 v62, v62
    v_exp_f32 v63, v63
    s_nop 1
    v_smfmac_f32_32x32x32_bf16 v[104:119], v[252:255], v[56:63], v10
L_b_fin:
    s_lshl_b32 s35, s32, 6
    s_add_u32 s35, s35, s31
    s_lshl_b32 s35, s35, 10
    s_add_u32 s35, s35, 0x608000
    s_min_u32 s30, s34, 9
    s_nop 7
    v_max3_f32 v4, |v104|, |v105|, |v106|
    v_max3_f32 v5, |v107|, |v108|, |v109|
    v_max3_f32 v4, v4, |v110|, |v111|
    s_mov_b32 s24, 0x21800000
    s_mov_b32 s25, 0x53800000
    s_mov_b32 s26, 0x7b800000
    v_add_f32 v4, v4, v5
    v_cmp_nlt_f32 vcc, s24, v112
    v_cmp_ngt_f32 s[38:39], s25, v112
    v_cmp_ngt_f32 s[40:41], s26, v4
    s_nop 1
    s_or_b64 vcc, vcc, s[38:39]
    s_or_b64 vcc, vcc, s[40:41]
    s_cbranch_vccnz L_b_slow0
L_b_ok0:
    v_rcp_f32 v4, v112
    s_nop 0
    v_mul_f32 v104, v104, v4
    v_mul_f32 v105, v105, v4
    v_mul_f32 v106, v106, v4
    v_mul_f32 v107, v107, v4
    v_mul_f32 v108, v108, v4
    v_mul_f32 v109, v109, v4
    v_mul_f32 v110, v110, v4
    v_mul_f32 v111, v111, v4
    v_cvt_pk_bf16_f32 v64, v104, v105
    v_cvt_pk_bf16_f32 v65, v106, v107
    v_cvt_pk_bf16_f32 v66, v108, v109
    v_cvt_pk_bf16_f32 v67, v110, v111
    buffer_store_dwordx4 v[64:67], v2, s[12:15], s35 offen sc1
    s_add_u32 s35, s35, 65536
    s_add_u32 s29, s29, 2176
    s_add_u32 s30, s32, 2
    s_min_u32 s30, s30, 9
    v_max3_f32 v4, |v120|, |v121|, |v122|
    v_max3_f32 v5, |v123|, |v124|, |v125|
    v_max3_f32 v4, v4, |v126|, |v127|
    s_mov_b32 s24, 0x21800000
    s_mov_b32 s25, 0x53800000
    s_mov_b32 s26, 0x7b800000
    v_add_f32 v4, v4, v5
    v_cmp_nlt_f32 vcc, s24, v128
    v_cmp_ngt_f32 s[38:39], s25, v128
    v_cmp_ngt_f32 s[40:41], s26, v4
    s_nop 1
    s_or_b64 vcc, vcc, s[38:39]
    s_or_b64 vcc, vcc, s[40:41]
    s_cbranch_vccnz L_b_slow1
L_b_ok1:
    v_rcp_f32 v4, v128
    s_nop 0
    v_mul_f32 v120, v120, v4
    v_mul_f32 v121, v121, v4
    v_mul_f32 v122, v122, v4
    v_mul_f32 v123, v123, v4
    v_mul_f32 v124, v124, v4
    v_mul_f32 v125, v125, v4
    v_mul_f32 v126, v126, v4
    v_mul_f32 v127, v127, v4
    v_cvt_pk_bf16_f32 v68, v120, v121
    v_cvt_pk_bf16_f32 v69, v122, v123
    v_cvt_pk_bf16_f32 v70, v124, v125
    v_cvt_pk_bf16_f32 v71, v126, v127
    buffer_store_dwordx4 v[68:71], v2, s[12:15], s35 offen sc1
    s_waitcnt vmcnt(0)
    v_mov_b32 v4, 156680
    v_mov_b32 v5, 1
    s_mov_b64 exec, 1
    ds_add_rtn_u32 v5, v4, v5
    s_waitcnt lgkmcnt(0)
    s_mov_b64 exec, -1
    v_readfirstlane_b32 s24, v5
    s_nop 1
    s_cmp_lg_u32 s24, 3
    s_cbranch_scc1 L_b_ob_nl
    s_lshl_b32 s26, s18, 8
    s_lshl_b32 s27, s17, 5
    s_add_u32 s26, s26, s27
    s_add_u32 s26, s26, 0x44000
    v_mov_b32 v4, s19
    v_mov_b32 v5, 0
    s_mov_b64 exec, 1
    buffer_store_dword v4, v5, s[12:15], s26 offen sc1
    s_mov_b64 exec, -1
L_b_ob_nl:
    s_and_b32 s27, s28, 1
    s_lshr_b32 s26, s28, 1
    v_lshrrev_b32 v4, 5, v1
    v_bfe_u32 v5, v1, 2, 2
    v_mad_u32_u24 v4, v4, 4, v5
    v_and_b32 v5, 3, v1
    v_lshlrev_b32 v5, 3, v5
    v_lshl_add_u32 v4, v4, 7, v5
    v_bfe_u32 v5, v1, 4, 1
    v_lshl_add_u32 v4, v5, 5, v4
    v_bfe_u32 v5, v1, 3, 1
    v_xor_b32 v5, s26, v5
    v_lshl_add_u32 v4, v5, 6, v4
    v_mov_b32 v13, v4
    v_and_b32 v6, 7, v1
    v_lshlrev_b32 v6, 5, v6
    s_lshl_b32 s26, s18, 8
    s_add_u32 s26, s26, 0x44000
    s_mov_b32 s55, 16
L_wA:
    s_lshl_b32 s57, s56, 10
    s_add_u32 s57, s57, s37
    s_add_u32 m0, s57, 65536
    s_lshl_b32 s57, s56, 13
    s_add_u32 s57, s57, s54
    buffer_load_dwordx4 v11, s[20:23], s57 offen lds
    s_add_u32 s56, s56, 1
    s_and_b32 s56, s56, 15
    s_sub_u32 s55, s55, 1
    s_waitcnt vmcnt(5)
    s_cmp_lg_u32 s55, 0
    s_cbranch_scc1 L_wA
    s_waitcnt vmcnt(0)
    v_mov_b32 v4, 156684
    v_mov_b32 v5, 1
    s_mov_b64 exec, 1
    ds_add_u32 v4, v5
    s_mov_b64 exec, -1
    v_add_u32 v12, 65536, v13
    v_mov_b32 v4, 156684
    s_mov_b32 s36, 400000
tw_46:
    ds_read_b32 v5, v4
    s_waitcnt lgkmcnt(0)
    v_readfirstlane_b32 s24, v5
    s_nop 1
    s_cmp_ge_u32 s24, 4
    s_cbranch_scc1 twd_47
    s_sub_u32 s36, s36, 1
    s_cbranch_scc1 twd_47
    s_sleep 2
    s_branch tw_46
twd_47:
    ds_read_b64_tr_b16 v[128:129], v12 offset:0
    ds_read_b64_tr_b16 v[130:131], v12 offset:1024
    ds_read_b64_tr_b16 v[132:133], v12 offset:2048
    ds_read_b64_tr_b16 v[134:135], v12 offset:3072
    ds_read_b64_tr_b16 v[136:137], v12 offset:4096
    ds_read_b64_tr_b16 v[138:139], v12 offset:5120
    ds_read_b64_tr_b16 v[140:141], v12 offset:6144
    ds_read_b64_tr_b16 v[142:143], v12 offset:7168
    ds_read_b64_tr_b16 v[144:145], v12 offset:8192
    ds_read_b64_tr_b16 v[146:147], v12 offset:9216
    ds_read_b64_tr_b16 v[148:149], v12 offset:10240
    ds_read_b64_tr_b16 v[150:151], v12 offset:11264
    ds_read_b64_tr_b16 v[152:153], v12 offset:12288
    ds_read_b64_tr_b16 v[154:155], v12 offset:13312
    s_waitcnt lgkmcnt(0)
    ds_read_b64_tr_b16 v[156:157], v12 offset:14336
    ds_read_b64_tr_b16 v[158:159], v12 offset:15360
    ds_read_b64_tr_b16 v[160:161], v12 offset:16384
    ds_read_b64_tr_b16 v[162:163], v12 offset:17408
    ds_read_b64_tr_b16 v[164:165], v12 offset:18432
    ds_read_b64_tr_b16 v[166:167], v12 offset:19456
    ds_read_b64_tr_b16 v[168:169], v12 offset:20480
    ds_read_b64_tr_b16 v[170:171], v12 offset:21504
    ds_read_b64_tr_b16 v[172:173], v12 offset:22528
    ds_read_b64_tr_b16 v[174:175], v12 offset:23552
    ds_read_b64_tr_b16 v[176:177], v12 offset:24576
    ds_read_b64_tr_b16 v[178:179], v12 offset:25600
    ds_read_b64_tr_b16 v[180:181], v12 offset:26624
    ds_read_b64_tr_b16 v[182:183], v12 offset:27648
    s_waitcnt lgkmcnt(0)
    ds_read_b64_tr_b16 v[184:185], v12 offset:28672
    ds_read_b64_tr_b16 v[186:187], v12 offset:29696
    ds_read_b64_tr_b16 v[188:189], v12 offset:30720
    ds_read_b64_tr_b16 v[190:191], v12 offset:31744
    ds_read_b64_tr_b16 v[192:193], v12 offset:32768
    ds_read_b64_tr_b16 v[194:195], v12 offset:33792
    ds_read_b64_tr_b16 v[196:197], v12 offset:34816
    ds_read_b64_tr_b16 v[198:199], v12 offset:35840
    ds_read_b64_tr_b16 v[200:201], v12 offset:36864
    ds_read_b64_tr_b16 v[202:203], v12 offset:37888
    ds_read_b64_tr_b16 v[204:205], v12 offset:38912
    ds_read_b64_tr_b16 v[206:207], v12 offset:39936
    ds_read_b64_tr_b16 v[208:209], v12 offset:40960
    ds_read_b64_tr_b16 v[210:211], v12 offset:41984
    s_waitcnt lgkmcnt(0)
    ds_read_b64_tr_b16 v[212:213], v12 offset:43008
    ds_read_b64_tr_b16 v[214:215], v12 offset:44032
    ds_read_b64_tr_b16 v[216:217], v12 offset:45056
    ds_read_b64_tr_b16 v[218:219], v12 offset:46080
    ds_read_b64_tr_b16 v[220:221], v12 offset:47104
    ds_read_b64_tr_b16 v[222:223], v12 offset:48128
    ds_read_b64_tr_b16 v[224:225], v12 offset:49152
    ds_read_b64_tr_b16 v[226:227], v12 offset:50176
    ds_read_b64_tr_b16 v[228:229], v12 offset:51200
    ds_read_b64_tr_b16 v[230:231], v12 offset:52224
    ds_read_b64_tr_b16 v[232:233], v12 offset:53248
    ds_read_b64_tr_b16 v[234:235], v12 offset:54272
    ds_read_b64_tr_b16 v[236:237], v12 offset:55296
    ds_read_b64_tr_b16 v[238:239], v12 offset:56320
    s_waitcnt lgkmcnt(0)
    ds_read_b64_tr_b16 v[240:241], v12 offset:57344
    ds_read_b64_tr_b16 v[242:243], v12 offset:58368
    ds_read_b64_tr_b16 v[244:245], v12 offset:59392
    ds_read_b64_tr_b16 v[246:247], v12 offset:60416
    ds_read_b64_tr_b16 v[248:249], v12 offset:61440
    ds_read_b64_tr_b16 v[250:251], v12 offset:62464
    ds_read_b64_tr_b16 v[252:253], v12 offset:63488
    ds_read_b64_tr_b16 v[254:255], v12 offset:64512
    s_waitcnt lgkmcnt(0)
    v_mov_b32 v4, 156720
    v_mov_b32 v5, 1
    s_mov_b64 exec, 1
    ds_add_u32 v4, v5
    s_mov_b64 exec, -1
    s_mov_b32 s36, 400000
poll_48:
    buffer_load_dword v5, v6, s[12:15], s26 offen sc1
    s_waitcnt vmcnt(0)
    v_cmp_ne_u32 vcc, s19, v5
    s_nop 1
    s_cbranch_vccz polld_49
    s_mov_b64 exec, vcc
    s_sub_u32 s36, s36, 1
    s_cbranch_scc1 polld_49
    s_sleep 2
    s_branch poll_48
polld_49:
    s_mov_b64 exec, -1
    s_add_u32 s54, s32, s27
    s_lshl_b32 s54, s54, 16
    s_lshr_b32 s33, s28, 1
    s_lshl_b32 s33, s33, 14
    s_add_u32 s54, s54, s33
    s_add_u32 s54, s54, 0x608000
    s_lshl_b32 s37, s27, 15
    s_add_u32 s37, s37, s33
    s_add_u32 s37, s37, 65536
    v_mov_b32 v4, 156720
    s_mov_b32 s36, 400000
tw_50:
    ds_read_b32 v5, v4
    s_waitcnt lgkmcnt(0)
    v_readfirstlane_b32 s24, v5
    s_nop 1
    s_cmp_ge_u32 s24, 4
    s_cbranch_scc1 twd_51
    s_sub_u32 s36, s36, 1
    s_cbranch_scc1 twd_51
    s_sleep 2
    s_branch tw_50
twd_51:
    s_mov_b32 s55, 16
L_oB:
    s_mov_b32 m0, s37
    s_add_u32 s37, s37, 1024
    buffer_load_dwordx4 v2, s[12:15], s54 offen sc1 lds
    s_add_u32 s54, s54, 1024
    s_sub_u32 s55, s55, 1
    s_waitcnt vmcnt(5)
    s_cmp_lg_u32 s55, 0
    s_cbranch_scc1 L_oB
L_b_skip:
    s_and_b32 s27, s28, 1
    s_mov_b32 s4, s62
    s_and_b32 s5, s63, 0xffff
    s_mov_b32 s6, 0x200000
    s_mov_b32 s7, 0x00020000
    v_and_b32 v4, 31, v1
    v_lshlrev_b32 v4, 10, v4
    v_lshrrev_b32 v5, 5, v1
    v_lshl_add_u32 v8, v5, 4, v4
    s_add_u32 s29, s32, s27
    s_lshl_b32 s29, s29, 15
    s_lshl_b32 s24, s17, 7
    s_add_u32 s29, s29, s24
    s_lshr_b32 s24, s28, 1
    s_lshl_b32 s24, s24, 6
    s_add_u32 s29, s29, s24
    s_lshl_b32 s24, s27, 15
    v_add_u32 v9, s24, v2
    s_lshl_b32 s35, s18, 8
    s_lshl_b32 s24, s17, 5
    s_add_u32 s35, s35, s24
    s_add_u32 s35, s35, 0x46000
    v_add_u32 v12, 65536, v9
    s_waitcnt vmcnt(0) lgkmcnt(0)
    s_setprio 0
    s_barrier
    ds_read_b64_tr_b16 v[64:65], v13 offset:0
    ds_read_b64_tr_b16 v[66:67], v13 offset:1024
    ds_read_b128 v[68:71], v12 offset:0
    ds_read_b64_tr_b16 v[72:73], v13 offset:2048
    ds_read_b64_tr_b16 v[74:75], v13 offset:3072
    ds_read_b128 v[76:79], v12 offset:1024
    ds_read_b64_tr_b16 v[80:81], v13 offset:4096
    ds_read_b64_tr_b16 v[82:83], v13 offset:5120
    ds_read_b128 v[84:87], v12 offset:2048
    ds_read_b64_tr_b16 v[88:89], v13 offset:6144
    ds_read_b64_tr_b16 v[90:91], v13 offset:7168
    ds_read_b128 v[92:95], v12 offset:3072
    s_waitcnt lgkmcnt(9)
    v_mfma_f32_32x32x16_bf16 v[16:31], v[64:67], v[68:71], 0
    ds_read_b64_tr_b16 v[64:65], v13 offset:8192
    ds_read_b64_tr_b16 v[66:67], v13 offset:9216
    ds_read_b128 v[68:71], v12 offset:4096
    s_waitcnt lgkmcnt(9)
    v_mfma_f32_32x32x16_bf16 v[16:31], v[72:75], v[76:79], v[16:31]
    ds_read_b64_tr_b16 v[72:73], v13 offset:10240
    ds_read_b64_tr_b16 v[74:75], v13 offset:11264
    ds_read_b128 v[76:79], v12 offset:5120
    s_waitcnt lgkmcnt(9)
    v_mfma_f32_32x32x16_bf16 v[16:31], v[80:83], v[84:87], v[16:31]
    ds_read_b64_tr_b16 v[80:81], v13 offset:12288
    ds_read_b64_tr_b16 v[82:83], v13 offset:13312
    ds_read_b128 v[84:87], v12 offset:6144
    s_waitcnt lgkmcnt(9)
    v_mfma_f32_32x32x16_bf16 v[16:31], v[88:91], v[92:95], v[16:31]
    ds_read_b64_tr_b16 v[88:89], v13 offset:14336
    ds_read_b64_tr_b16 v[90:91], v13 offset:15360
    ds_read_b128 v[92:95], v12 offset:7168
    s_waitcnt lgkmcnt(9)
    v_mfma_f32_32x32x16_bf16 v[16:31], v[64:67], v[68:71], v[16:31]
    ds_read_b64_tr_b16 v[64:65], v13 offset:16384
    ds_read_b64_tr_b16 v[66:67], v13 offset:17408
    ds_read_b128 v[68:71], v12 offset:8192
    s_waitcnt lgkmcnt(9)
    v_mfma_f32_32x32x16_bf16 v[16:31], v[72:75], v[76:79], v[16:31]
    ds_read_b64_tr_b16 v[72:73], v13 offset:18432
    ds_read_b64_tr_b16 v[74:75], v13 offset:19456
    ds_read_b128 v[76:79], v12 offset:9216
    s_waitcnt lgkmcnt(9)
    v_mfma_f32_32x32x16_bf16 v[16:31], v[80:83], v[84:87], v[16:31]
    ds_read_b64_tr_b16 v[80:81], v13 offset:20480
    ds_read_b64_tr_b16 v[82:83], v13 offset:21504
    ds_read_b128 v[84:87], v12 offset:10240
    s_waitcnt lgkmcnt(9)
    v_mfma_f32_32x32x16_bf16 v[16:31], v[88:91], v[92:95], v[16:31]
    s_barrier
    ds_read_b64_tr_b16 v[88:89], v13 offset:22528
    ds_read_b64_tr_b16 v[90:91], v13 offset:23552
    ds_read_b128 v[92:95], v12 offset:11264
    s_waitcnt lgkmcnt(9)
    v_mfma_f32_32x32x16_bf16 v[16:31], v[64:67], v[68:71], v[16:31]
    ds_read_b64_tr_b16 v[64:65], v13 offset:24576
    ds_read_b64_tr_b16 v[66:67], v13 offset:25600
    ds_read_b128 v[68:71], v12 offset:12288
    s_waitcnt lgkmcnt(9)
    v_mfma_f32_32x32x16_bf16 v[16:31], v[72:75], v[76:79], v[16:31]
    ds_read_b64_tr_b16 v[72:73], v13 offset:26624
    ds_read_b64_tr_b16 v[74:75], v13 offset:27648
    ds_read_b128 v[76:79], v12 offset:13312
    s_waitcnt lgkmcnt(9)
    v_mfma_f32_32x32x16_bf16 v[16:31], v[80:83], v[84:87], v[16:31]
    ds_read_b64_tr_b16 v[80:81], v13 offset:28672
    ds_read_b64_tr_b16 v[82:83], v13 offset:29696
    ds_read_b128 v[84:87], v12 offset:14336
    s_waitcnt lgkmcnt(9)
    v_mfma_f32_32x32x16_bf16 v[16:31], v[88:91], v[92:95], v[16:31]
    ds_read_b64_tr_b16 v[88:89], v13 offset:30720
    ds_read_b64_tr_b16 v[90:91], v13 offset:31744
    ds_read_b128 v[92:95], v12 offset:15360
    s_waitcnt lgkmcnt(9)
    v_mfma_f32_32x32x16_bf16 v[16:31], v[64:67], v[68:71], v[16:31]
    ds_read_b64_tr_b16 v[64:65], v13 offset:32768
    ds_read_b64_tr_b16 v[66:67], v13 offset:33792
    ds_read_b128 v[68:71], v12 offset:16384
    s_waitcnt lgkmcnt(9)
    v_mfma_f32_32x32x16_bf16 v[16:31], v[72:75], v[76:79], v[16:31]
    ds_read_b64_tr_b16 v[72:73], v13 offset:34816
    ds_read_b64_tr_b16 v[74:75], v13 offset:35840
    ds_read_b128 v[76:79], v12 offset:17408
    s_waitcnt lgkmcnt(9)
    v_mfma_f32_32x32x16_bf16 v[16:31], v[80:83], v[84:87], v[16:31]
    ds_read_b64_tr_b16 v[80:81], v13 offset:36864
    ds_read_b64_tr_b16 v[82:83], v13 offset:37888
    ds_read_b128 v[84:87], v12 offset:18432
    s_waitcnt lgkmcnt(9)
    v_mfma_f32_32x32x16_bf16 v[16:31], v[88:91], v[92:95], v[16:31]
    ds_read_b64_tr_b16 v[88:89], v13 offset:38912
    ds_read_b64_tr_b16 v[90:91], v13 offset:39936
    ds_read_b128 v[92:95], v12 offset:19456
    s_waitcnt lgkmcnt(9)
    v_mfma_f32_32x32x16_bf16 v[16:31], v[64:67], v[68:71], v[16:31]
    ds_read_b64_tr_b16 v[64:65], v13 offset:40960
    ds_read_b64_tr_b16 v[66:67], v13 offset:41984
    ds_read_b128 v[68:71], v12 offset:20480
    s_waitcnt lgkmcnt(9)
    v_mfma_f32_32x32x16_bf16 v[16:31], v[72:75], v[76:79], v[16:31]
    ds_read_b64_tr_b16 v[72:73], v13 offset:43008
    ds_read_b64_tr_b16 v[74:75], v13 offset:44032
    ds_read_b128 v[76:79], v12 offset:21504
    s_waitcnt lgkmcnt(9)
    v_mfma_f32_32x32x16_bf16 v[16:31], v[80:83], v[84:87], v[16:31]
    ds_read_b64_tr_b16 v[80:81], v13 offset:45056
    ds_read_b64_tr_b16 v[82:83], v13 offset:46080
    ds_read_b128 v[84:87], v12 offset:22528
    s_waitcnt lgkmcnt(9)
    v_mfma_f32_32x32x16_bf16 v[16:31], v[88:91], v[92:95], v[16:31]
    ds_read_b64_tr_b16 v[88:89], v13 offset:47104
    ds_read_b64_tr_b16 v[90:91], v13 offset:48128
    ds_read_b128 v[92:95], v12 offset:23552
    s_waitcnt lgkmcnt(9)
    v_mfma_f32_32x32x16_bf16 v[16:31], v[64:67], v[68:71], v[16:31]
    ds_read_b64_tr_b16 v[64:65], v13 offset:49152
    ds_read_b64_tr_b16 v[66:67], v13 offset:50176
    ds_read_b128 v[68:71], v12 offset:24576
    s_waitcnt lgkmcnt(9)
    v_mfma_f32_32x32x16_bf16 v[16:31], v[72:75], v[76:79], v[16:31]
    ds_read_b64_tr_b16 v[72:73], v13 offset:51200
    ds_read_b64_tr_b16 v[74:75], v13 offset:52224
    ds_read_b128 v[76:79], v12 offset:25600
    s_waitcnt lgkmcnt(9)
    v_mfma_f32_32x32x16_bf16 v[16:31], v[80:83], v[84:87], v[16:31]
    ds_read_b64_tr_b16 v[80:81], v13 offset:53248
    ds_read_b64_tr_b16 v[82:83], v13 offset:54272
    ds_read_b128 v[84:87], v12 offset:26624
    s_waitcnt lgkmcnt(9)
    v_mfma_f32_32x32x16_bf16 v[16:31], v[88:91], v[92:95], v[16:31]
    ds_read_b64_tr_b16 v[88:89], v13 offset:55296
    ds_read_b64_tr_b16 v[90:91], v13 offset:56320
    ds_read_b128 v[92:95], v12 offset:27648
    s_waitcnt lgkmcnt(9)
    v_mfma_f32_32x32x16_bf16 v[16:31], v[64:67], v[68:71], v[16:31]
    ds_read_b64_tr_b16 v[64:65], v13 offset:57344
    ds_read_b64_tr_b16 v[66:67], v13 offset:58368
    ds_read_b128 v[68:71], v12 offset:28672
    s_waitcnt lgkmcnt(9)
    v_mfma_f32_32x32x16_bf16 v[16:31], v[72:75], v[76:79], v[16:31]
    ds_read_b64_tr_b16 v[72:73], v13 offset:59392
    ds_read_b64_tr_b16 v[74:75], v13 offset:60416
    ds_read_b128 v[76:79], v12 offset:29696
    s_waitcnt lgkmcnt(9)
    v_mfma_f32_32x32x16_bf16 v[16:31], v[80:83], v[84:87], v[16:31]
    ds_read_b64_tr_b16 v[80:81], v13 offset:61440
    ds_read_b64_tr_b16 v[82:83], v13 offset:62464
    ds_read_b128 v[84:87], v12 offset:30720
    s_waitcnt lgkmcnt(9)
    v_mfma_f32_32x32x16_bf16 v[16:31], v[88:91], v[92:95], v[16:31]
    ds_read_b64_tr_b16 v[88:89], v13 offset:63488
    ds_read_b64_tr_b16 v[90:91], v13 offset:64512
    ds_read_b128 v[92:95], v12 offset:31744
    s_waitcnt lgkmcnt(9)
    v_mfma_f32_32x32x16_bf16 v[16:31], v[64:67], v[68:71], v[16:31]
    s_waitcnt lgkmcnt(6)
    v_mfma_f32_32x32x16_bf16 v[16:31], v[72:75], v[76:79], v[16:31]
    s_waitcnt lgkmcnt(3)
    v_mfma_f32_32x32x16_bf16 v[16:31], v[80:83], v[84:87], v[16:31]
    s_waitcnt lgkmcnt(0)
    v_mfma_f32_32x32x16_bf16 v[16:31], v[88:91], v[92:95], v[16:31]
    v_and_b32 v4, 7, v1
    v_lshlrev_b32 v4, 5, v4
    s_lshl_b32 s26, s18, 8
    s_add_u32 s26, s26, 0x46000
    s_and_b32 s24, s16, 1
    s_lshr_b32 s25, s16, 1
    s_lshl_b32 s33, s24, 15
    s_lshl_b32 s34, s18, 1
    s_add_u32 s34, s34, s24
    s_lshl_b32 s34, s34, 16
    s_add_u32 s34, s34, 0x600000
    s_mul_i32 s40, s25, 2048
    s_add_u32 s40, s40, 0
    s_mul_i32 s41, s25, 2048
    s_add_u32 s41, s41, 8192
    s_mul_i32 s42, s25, 2048
    s_add_u32 s42, s42, 16384
    s_mul_i32 s43, s25, 2048
    s_add_u32 s43, s43, 24576
tp_52:
    s_barrier
    s_add_u32 m0, s33, s40
    s_add_u32 s24, s34, s40
    buffer_load_dwordx4 v2, s[12:15], s24 offen offset:0 sc1 lds
    buffer_load_dwordx4 v2, s[12:15], s24 offen offset:1024 sc1 lds
    s_add_u32 m0, s33, s41
    s_add_u32 s24, s34, s41
    buffer_load_dwordx4 v2, s[12:15], s24 offen offset:0 sc1 lds
    buffer_load_dwordx4 v2, s[12:15], s24 offen offset:1024 sc1 lds
    s_add_u32 m0, s33, s42
    s_add_u32 s24, s34, s42
    buffer_load_dwordx4 v2, s[12:15], s24 offen offset:0 sc1 lds
    buffer_load_dwordx4 v2, s[12:15], s24 offen offset:1024 sc1 lds
    s_add_u32 m0, s33, s43
    s_add_u32 s24, s34, s43
    buffer_load_dwordx4 v2, s[12:15], s24 offen offset:0 sc1 lds
    buffer_load_dwordx4 v2, s[12:15], s24 offen offset:1024 sc1 lds
    v_sub_f32 v6, 1.0, v15
    v_mov_b32 v14, v15
    v_mul_f32 v16, v16, v6
    v_mul_f32 v17, v17, v6
    v_mul_f32 v18, v18, v6
    v_mul_f32 v19, v19, v6
    v_mul_f32 v20, v20, v6
    v_mul_f32 v21, v21, v6
    v_mul_f32 v22, v22, v6
    v_mul_f32 v23, v23, v6
    v_mul_f32 v24, v24, v6
    v_mul_f32 v25, v25, v6
    v_mul_f32 v26, v26, v6
    v_mul_f32 v27, v27, v6
    v_mul_f32 v28, v28, v6
    v_mul_f32 v29, v29, v6
    v_mul_f32 v30, v30, v6
    v_mul_f32 v31, v31, v6
    s_waitcnt vmcnt(6)
    s_barrier
    ds_read_b128 v[64:67], v9 offset:0
    ds_read_b128 v[68:71], v9 offset:1024
    ds_read_b128 v[72:75], v9 offset:2048
    ds_read_b128 v[76:79], v9 offset:3072
    ds_read_b128 v[80:83], v9 offset:4096
    ds_read_b128 v[84:87], v9 offset:5120
    ds_read_b128 v[88:91], v9 offset:6144
    ds_read_b128 v[92:95], v9 offset:7168
    s_waitcnt lgkmcnt(7)
    v_mfma_f32_32x32x16_bf16 v[32:47], v[128:131], v[64:67], 0
    s_waitcnt lgkmcnt(6)
    v_mfma_f32_32x32x16_bf16 v[32:47], v[132:135], v[68:71], v[32:47]
    s_waitcnt lgkmcnt(5)
    v_mfma_f32_32x32x16_bf16 v[32:47], v[136:139], v[72:75], v[32:47]
    s_waitcnt lgkmcnt(4)
    v_mfma_f32_32x32x16_bf16 v[32:47], v[140:143], v[76:79], v[32:47]
    s_waitcnt lgkmcnt(3)
    v_mfma_f32_32x32x16_bf16 v[32:47], v[144:147], v[80:83], v[32:47]
    s_waitcnt lgkmcnt(2)
    v_mfma_f32_32x32x16_bf16 v[32:47], v[148:151], v[84:87], v[32:47]
    s_waitcnt lgkmcnt(1)
    v_mfma_f32_32x32x16_bf16 v[32:47], v[152:155], v[88:91], v[32:47]
    s_waitcnt lgkmcnt(0)
    v_mfma_f32_32x32x16_bf16 v[32:47], v[156:159], v[92:95], v[32:47]
    s_waitcnt vmcnt(4)
    s_barrier
    ds_read_b128 v[64:67], v9 offset:8192
    ds_read_b128 v[68:71], v9 offset:9216
    ds_read_b128 v[72:75], v9 offset:10240
    ds_read_b128 v[76:79], v9 offset:11264
    ds_read_b128 v[80:83], v9 offset:12288
    ds_read_b128 v[84:87], v9 offset:13312
    ds_read_b128 v[88:91], v9 offset:14336
    ds_read_b128 v[92:95], v9 offset:15360
    s_waitcnt lgkmcnt(7)
    v_mfma_f32_32x32x16_bf16 v[32:47], v[160:163], v[64:67], v[32:47]
    s_waitcnt lgkmcnt(6)
    v_mfma_f32_32x32x16_bf16 v[32:47], v[164:167], v[68:71], v[32:47]
    s_waitcnt lgkmcnt(5)
    v_mfma_f32_32x32x16_bf16 v[32:47], v[168:171], v[72:75], v[32:47]
    s_waitcnt lgkmcnt(4)
    v_mfma_f32_32x32x16_bf16 v[32:47], v[172:175], v[76:79], v[32:47]
    s_waitcnt lgkmcnt(3)
    v_mfma_f32_32x32x16_bf16 v[32:47], v[176:179], v[80:83], v[32:47]
    s_waitcnt lgkmcnt(2)
    v_mfma_f32_32x32x16_bf16 v[32:47], v[180:183], v[84:87], v[32:47]
    s_waitcnt lgkmcnt(1)
    v_mfma_f32_32x32x16_bf16 v[32:47], v[184:187], v[88:91], v[32:47]
    s_waitcnt lgkmcnt(0)
    v_mfma_f32_32x32x16_bf16 v[32:47], v[188:191], v[92:95], v[32:47]
    s_waitcnt vmcnt(2)
    s_barrier
    ds_read_b128 v[64:67], v9 offset:16384
    ds_read_b128 v[68:71], v9 offset:17408
    ds_read_b128 v[72:75], v9 offset:18432
    ds_read_b128 v[76:79], v9 offset:19456
    ds_read_b128 v[80:83], v9 offset:20480
    ds_read_b128 v[84:87], v9 offset:21504
    ds_read_b128 v[88:91], v9 offset:22528
    ds_read_b128 v[92:95], v9 offset:23552
    s_waitcnt lgkmcnt(7)
    v_mfma_f32_32x32x16_bf16 v[32:47], v[192:195], v[64:67], v[32:47]
    s_waitcnt lgkmcnt(6)
    v_mfma_f32_32x32x16_bf16 v[32:47], v[196:199], v[68:71], v[32:47]
    s_waitcnt lgkmcnt(5)
    v_mfma_f32_32x32x16_bf16 v[32:47], v[200:203], v[72:75], v[32:47]
    s_waitcnt lgkmcnt(4)
    v_mfma_f32_32x32x16_bf16 v[32:47], v[204:207], v[76:79], v[32:47]
    s_waitcnt lgkmcnt(3)
    v_mfma_f32_32x32x16_bf16 v[32:47], v[208:211], v[80:83], v[32:47]
    s_waitcnt lgkmcnt(2)
    v_mfma_f32_32x32x16_bf16 v[32:47], v[212:215], v[84:87], v[32:47]
    s_waitcnt lgkmcnt(1)
    v_mfma_f32_32x32x16_bf16 v[32:47], v[216:219], v[88:91], v[32:47]
    s_waitcnt lgkmcnt(0)
    v_mfma_f32_32x32x16_bf16 v[32:47], v[220:223], v[92:95], v[32:47]
    s_waitcnt vmcnt(0)
    s_barrier
    ds_read_b128 v[64:67], v9 offset:24576
    ds_read_b128 v[68:71], v9 offset:25600
    ds_read_b128 v[72:75], v9 offset:26624
    ds_read_b128 v[76:79], v9 offset:27648
    ds_read_b128 v[80:83], v9 offset:28672
    ds_read_b128 v[84:87], v9 offset:29696
    ds_read_b128 v[88:91], v9 offset:30720
    ds_read_b128 v[92:95], v9 offset:31744
    s_waitcnt lgkmcnt(7)
    v_mfma_f32_32x32x16_bf16 v[32:47], v[224:227], v[64:67], v[32:47]
    s_waitcnt lgkmcnt(6)
    v_mfma_f32_32x32x16_bf16 v[32:47], v[228:231], v[68:71], v[32:47]
    s_waitcnt lgkmcnt(5)
    v_mfma_f32_32x32x16_bf16 v[32:47], v[232:235], v[72:75], v[32:47]
    s_waitcnt lgkmcnt(4)
    v_mfma_f32_32x32x16_bf16 v[32:47], v[236:239], v[76:79], v[32:47]
    s_waitcnt lgkmcnt(3)
    v_mfma_f32_32x32x16_bf16 v[32:47], v[240:243], v[80:83], v[32:47]
    s_waitcnt lgkmcnt(2)
    v_mfma_f32_32x32x16_bf16 v[32:47], v[244:247], v[84:87], v[32:47]
    s_waitcnt lgkmcnt(1)
    v_mfma_f32_32x32x16_bf16 v[32:47], v[248:251], v[88:91], v[32:47]
    s_waitcnt lgkmcnt(0)
    v_mfma_f32_32x32x16_bf16 v[32:47], v[252:255], v[92:95], v[32:47]
    s_nop 7
    s_nop 3
    v_pk_fma_f32 v[16:17], v[32:33], v[14:15], v[16:17]
    v_pk_fma_f32 v[18:19], v[34:35], v[14:15], v[18:19]
    v_pk_fma_f32 v[20:21], v[36:37], v[14:15], v[20:21]
    v_pk_fma_f32 v[22:23], v[38:39], v[14:15], v[22:23]
    v_pk_fma_f32 v[24:25], v[40:41], v[14:15], v[24:25]
    v_pk_fma_f32 v[26:27], v[42:43], v[14:15], v[26:27]
    v_pk_fma_f32 v[28:29], v[44:45], v[14:15], v[28:29]
    v_pk_fma_f32 v[30:31], v[46:47], v[14:15], v[30:31]
    v_cvt_pk_bf16_f32 v64, v16, v17
    v_cvt_pk_bf16_f32 v65, v18, v19
    v_cvt_pk_bf16_f32 v66, v20, v21
    v_cvt_pk_bf16_f32 v67, v22, v23
    v_cvt_pk_bf16_f32 v68, v24, v25
    v_cvt_pk_bf16_f32 v69, v26, v27
    v_cvt_pk_bf16_f32 v70, v28, v29
    v_cvt_pk_bf16_f32 v71, v30, v31
    s_nop 1
    v_permlane32_swap_b32 v64, v66
    v_permlane32_swap_b32 v65, v67
    v_permlane32_swap_b32 v68, v70
    v_permlane32_swap_b32 v69, v71
    buffer_store_dwordx4 v[64:67], v8, s[4:7], s29 offen offset:0
    buffer_store_dwordx4 v[68:71], v8, s[4:7], s29 offen offset:32
L_exit:
    s_endpgm
L_b_exit1:
    s_nop 0
    v_smfmac_f32_32x32x32_bf16 v[120:135], v[156:159], v[40:47], v10
    s_branch L_b_fin
L_b_exit3:
    s_nop 0
    v_smfmac_f32_32x32x32_bf16 v[120:135], v[180:183], v[40:47], v10
    s_branch L_b_fin
L_b_exit5:
    s_nop 0
    v_smfmac_f32_32x32x32_bf16 v[120:135], v[204:207], v[40:47], v10
    s_branch L_b_fin
L_b_exit7:
    s_nop 0
    v_smfmac_f32_32x32x32_bf16 v[120:135], v[228:231], v[40:47], v10
    s_branch L_b_fin
L_b_slow0:
    s_waitcnt vmcnt(0) lgkmcnt(0)
    v_mov_b32 v9, 0xfe967699
    v_mov_b32 v7, v9
    s_mov_b32 s33, s29
    s_mov_b32 s34, 0
sp1_53:
    buffer_load_dwordx4 v[136:139], v2, s[12:15], s33 offen sc1
    s_cmp_eq_u32 s34, 0
    s_cbranch_scc1 m0_55
    s_cmp_eq_u32 s34, 8
    s_cbranch_scc1 m8_56
    v_mov_b32 v152, 0
    v_mov_b32 v153, 0
    v_mov_b32 v154, 0
    v_mov_b32 v155, 0
    v_mov_b32 v156, 0
    v_mov_b32 v157, 0
    v_mov_b32 v158, 0
    v_mov_b32 v159, 0
    v_mov_b32 v160, 0
    v_mov_b32 v161, 0
    v_mov_b32 v162, 0
    v_mov_b32 v163, 0
    v_mov_b32 v164, 0
    v_mov_b32 v165, 0
    v_mov_b32 v166, 0
    v_mov_b32 v167, 0
    s_branch md_57
m0_55:
    s_mov_b32 s40, 0x0
    s_mov_b32 s41, 0xf
    v_cndmask_b32_e64 v152, 0, v9, s[40:41]
    s_mov_b32 s42, 0x1
    s_mov_b32 s43, 0x1f
    v_cndmask_b32_e64 v153, 0, v9, s[42:43]
    s_mov_b32 s40, 0x3
    s_mov_b32 s41, 0x3f
    v_cndmask_b32_e64 v154, 0, v9, s[40:41]
    s_mov_b32 s42, 0x7
    s_mov_b32 s43, 0x7f
    v_cndmask_b32_e64 v155, 0, v9, s[42:43]
    s_mov_b32 s40, 0xff
    s_mov_b32 s41, 0xfff
    v_cndmask_b32_e64 v156, 0, v9, s[40:41]
    s_mov_b32 s42, 0x1ff
    s_mov_b32 s43, 0x1fff
    v_cndmask_b32_e64 v157, 0, v9, s[42:43]
    s_mov_b32 s40, 0x3ff
    s_mov_b32 s41, 0x3fff
    v_cndmask_b32_e64 v158, 0, v9, s[40:41]
    s_mov_b32 s42, 0x7ff
    s_mov_b32 s43, 0x7fff
    v_cndmask_b32_e64 v159, 0, v9, s[42:43]
    s_mov_b32 s40, 0xffff
    s_mov_b32 s41, 0xfffff
    v_cndmask_b32_e64 v160, 0, v9, s[40:41]
    s_mov_b32 s42, 0x1ffff
    s_mov_b32 s43, 0x1fffff
    v_cndmask_b32_e64 v161, 0, v9, s[42:43]
    s_mov_b32 s40, 0x3ffff
    s_mov_b32 s41, 0x3fffff
    v_cndmask_b32_e64 v162, 0, v9, s[40:41]
    s_mov_b32 s42, 0x7ffff
    s_mov_b32 s43, 0x7fffff
    v_cndmask_b32_e64 v163, 0, v9, s[42:43]
    s_mov_b32 s40, 0xffffff
    s_mov_b32 s41, 0xfffffff
    v_cndmask_b32_e64 v164, 0, v9, s[40:41]
    s_mov_b32 s42, 0x1ffffff
    s_mov_b32 s43, 0x1fffffff
    v_cndmask_b32_e64 v165, 0, v9, s[42:43]
    s_mov_b32 s40, 0x3ffffff
    s_mov_b32 s41, 0x3fffffff
    v_cndmask_b32_e64 v166, 0, v9, s[40:41]
    s_mov_b32 s42, 0x7ffffff
    s_mov_b32 s43, 0x7fffffff
    v_cndmask_b32_e64 v167, 0, v9, s[42:43]
    s_branch md_57
m8_56:
    s_mov_b32 s40, 0x0
    s_mov_b32 s41, 0xf
    v_cndmask_b32_e64 v152, v9, 0, s[40:41]
    s_mov_b32 s42, 0x1
    s_mov_b32 s43, 0x1f
    v_cndmask_b32_e64 v153, v9, 0, s[42:43]
    s_mov_b32 s40, 0x3
    s_mov_b32 s41, 0x3f
    v_cndmask_b32_e64 v154, v9, 0, s[40:41]
    s_mov_b32 s42, 0x7
    s_mov_b32 s43, 0x7f
    v_cndmask_b32_e64 v155, v9, 0, s[42:43]
    s_mov_b32 s40, 0xff
    s_mov_b32 s41, 0xfff
    v_cndmask_b32_e64 v156, v9, 0, s[40:41]
    s_mov_b32 s42, 0x1ff
    s_mov_b32 s43, 0x1fff
    v_cndmask_b32_e64 v157, v9, 0, s[42:43]
    s_mov_b32 s40, 0x3ff
    s_mov_b32 s41, 0x3fff
    v_cndmask_b32_e64 v158, v9, 0, s[40:41]
    s_mov_b32 s42, 0x7ff
    s_mov_b32 s43, 0x7fff
    v_cndmask_b32_e64 v159, v9, 0, s[42:43]
    s_mov_b32 s40, 0xffff
    s_mov_b32 s41, 0xfffff
    v_cndmask_b32_e64 v160, v9, 0, s[40:41]
    s_mov_b32 s42, 0x1ffff
    s_mov_b32 s43, 0x1fffff
    v_cndmask_b32_e64 v161, v9, 0, s[42:43]
    s_mov_b32 s40, 0x3ffff
    s_mov_b32 s41, 0x3fffff
    v_cndmask_b32_e64 v162, v9, 0, s[40:41]
    s_mov_b32 s42, 0x7ffff
    s_mov_b32 s43, 0x7fffff
    v_cndmask_b32_e64 v163, v9, 0, s[42:43]
    s_mov_b32 s40, 0xffffff
    s_mov_b32 s41, 0xfffffff
    v_cndmask_b32_e64 v164, v9, 0, s[40:41]
    s_mov_b32 s42, 0x1ffffff
    s_mov_b32 s43, 0x1fffffff
    v_cndmask_b32_e64 v165, v9, 0, s[42:43]
    s_mov_b32 s40, 0x3ffffff
    s_mov_b32 s41, 0x3fffffff
    v_cndmask_b32_e64 v166, v9, 0, s[40:41]
    s_mov_b32 s42, 0x7ffffff
    s_mov_b32 s43, 0x7fffffff
    v_cndmask_b32_e64 v167, v9, 0, s[42:43]
md_57:
    s_waitcnt vmcnt(0)
    s_nop 1
    v_mfma_f32_32x32x16_bf16 v[32:47], v[136:139], v[96:99], v[152:167]
    s_add_u32 s33, s33, 0xfffff780
    s_add_u32 s34, s34, 1
    s_nop 15
    v_max3_f32 v7, v7, v32, v33
    v_max3_f32 v7, v7, v34, v35
    v_max3_f32 v7, v7, v36, v37
    v_max3_f32 v7, v7, v38, v39
    v_max3_f32 v7, v7, v40, v41
    v_max3_f32 v7, v7, v42, v43
    v_max3_f32 v7, v7, v44, v45
    v_max3_f32 v7, v7, v46, v47
    s_cmp_lt_u32 s34, s30
    s_cbranch_scc1 sp1_53
    v_mov_b32 v8, v7
    s_nop 1
    v_permlane32_swap_b32 v7, v8
    v_max_f32 v7, v7, v8
    v_mov_b32 v104, 0
    v_mov_b32 v105, 0
    v_mov_b32 v106, 0
    v_mov_b32 v107, 0
    v_mov_b32 v108, 0
    v_mov_b32 v109, 0
    v_mov_b32 v110, 0
    v_mov_b32 v111, 0
    v_mov_b32 v112, 0
    v_mov_b32 v113, 0
    v_mov_b32 v114, 0
    v_mov_b32 v115, 0
    v_mov_b32 v116, 0
    v_mov_b32 v117, 0
    v_mov_b32 v118, 0
    v_mov_b32 v119, 0
    s_mov_b32 s33, s29
    s_mov_b32 s34, 0
sp2_54:
    buffer_load_dwordx4 v[136:139], v2, s[12:15], s33 offen sc1
    buffer_load_dwordx4 v[140:143], v3, s[12:15], s33 offen sc1
    buffer_load_dwordx4 v[144:147], v0, s[12:15], s33 offen sc1
    s_cmp_eq_u32 s34, 0
    s_cbranch_scc1 m0_58
    s_cmp_eq_u32 s34, 8
    s_cbranch_scc1 m8_59
    v_mov_b32 v152, 0
    v_mov_b32 v153, 0
    v_mov_b32 v154, 0
    v_mov_b32 v155, 0
    v_mov_b32 v156, 0
    v_mov_b32 v157, 0
    v_mov_b32 v158, 0
    v_mov_b32 v159, 0
    v_mov_b32 v160, 0
    v_mov_b32 v161, 0
    v_mov_b32 v162, 0
    v_mov_b32 v163, 0
    v_mov_b32 v164, 0
    v_mov_b32 v165, 0
    v_mov_b32 v166, 0
    v_mov_b32 v167, 0
    s_branch md_60
m0_58:
    s_mov_b32 s40, 0x0
    s_mov_b32 s41, 0xf
    v_cndmask_b32_e64 v152, 0, v9, s[40:41]
    s_mov_b32 s42, 0x1
    s_mov_b32 s43, 0x1f
    v_cndmask_b32_e64 v153, 0, v9, s[42:43]
    s_mov_b32 s40, 0x3
    s_mov_b32 s41, 0x3f
    v_cndmask_b32_e64 v154, 0, v9, s[40:41]
    s_mov_b32 s42, 0x7
    s_mov_b32 s43, 0x7f
    v_cndmask_b32_e64 v155, 0, v9, s[42:43]
    s_mov_b32 s40, 0xff
    s_mov_b32 s41, 0xfff
    v_cndmask_b32_e64 v156, 0, v9, s[40:41]
    s_mov_b32 s42, 0x1ff
    s_mov_b32 s43, 0x1fff
    v_cndmask_b32_e64 v157, 0, v9, s[42:43]
    s_mov_b32 s40, 0x3ff
    s_mov_b32 s41, 0x3fff
    v_cndmask_b32_e64 v158, 0, v9, s[40:41]
    s_mov_b32 s42, 0x7ff
    s_mov_b32 s43, 0x7fff
    v_cndmask_b32_e64 v159, 0, v9, s[42:43]
    s_mov_b32 s40, 0xffff
    s_mov_b32 s41, 0xfffff
    v_cndmask_b32_e64 v160, 0, v9, s[40:41]
    s_mov_b32 s42, 0x1ffff
    s_mov_b32 s43, 0x1fffff
    v_cndmask_b32_e64 v161, 0, v9, s[42:43]
    s_mov_b32 s40, 0x3ffff
    s_mov_b32 s41, 0x3fffff
    v_cndmask_b32_e64 v162, 0, v9, s[40:41]
    s_mov_b32 s42, 0x7ffff
    s_mov_b32 s43, 0x7fffff
    v_cndmask_b32_e64 v163, 0, v9, s[42:43]
    s_mov_b32 s40, 0xffffff
    s_mov_b32 s41, 0xfffffff
    v_cndmask_b32_e64 v164, 0, v9, s[40:41]
    s_mov_b32 s42, 0x1ffffff
    s_mov_b32 s43, 0x1fffffff
    v_cndmask_b32_e64 v165, 0, v9, s[42:43]
    s_mov_b32 s40, 0x3ffffff
    s_mov_b32 s41, 0x3fffffff
    v_cndmask_b32_e64 v166, 0, v9, s[40:41]
    s_mov_b32 s42, 0x7ffffff
    s_mov_b32 s43, 0x7fffffff
    v_cndmask_b32_e64 v167, 0, v9, s[42:43]
    s_branch md_60
m8_59:
    s_mov_b32 s40, 0x0
    s_mov_b32 s41, 0xf
    v_cndmask_b32_e64 v152, v9, 0, s[40:41]
    s_mov_b32 s42, 0x1
    s_mov_b32 s43, 0x1f
    v_cndmask_b32_e64 v153, v9, 0, s[42:43]
    s_mov_b32 s40, 0x3
    s_mov_b32 s41, 0x3f
    v_cndmask_b32_e64 v154, v9, 0, s[40:41]
    s_mov_b32 s42, 0x7
    s_mov_b32 s43, 0x7f
    v_cndmask_b32_e64 v155, v9, 0, s[42:43]
    s_mov_b32 s40, 0xff
    s_mov_b32 s41, 0xfff
    v_cndmask_b32_e64 v156, v9, 0, s[40:41]
    s_mov_b32 s42, 0x1ff
    s_mov_b32 s43, 0x1fff
    v_cndmask_b32_e64 v157, v9, 0, s[42:43]
    s_mov_b32 s40, 0x3ff
    s_mov_b32 s41, 0x3fff
    v_cndmask_b32_e64 v158, v9, 0, s[40:41]
    s_mov_b32 s42, 0x7ff
    s_mov_b32 s43, 0x7fff
    v_cndmask_b32_e64 v159, v9, 0, s[42:43]
    s_mov_b32 s40, 0xffff
    s_mov_b32 s41, 0xfffff
    v_cndmask_b32_e64 v160, v9, 0, s[40:41]
    s_mov_b32 s42, 0x1ffff
    s_mov_b32 s43, 0x1fffff
    v_cndmask_b32_e64 v161, v9, 0, s[42:43]
    s_mov_b32 s40, 0x3ffff
    s_mov_b32 s41, 0x3fffff
    v_cndmask_b32_e64 v162, v9, 0, s[40:41]
    s_mov_b32 s42, 0x7ffff
    s_mov_b32 s43, 0x7fffff
    v_cndmask_b32_e64 v163, v9, 0, s[42:43]
    s_mov_b32 s40, 0xffffff
    s_mov_b32 s41, 0xfffffff
    v_cndmask_b32_e64 v164, v9, 0, s[40:41]
    s_mov_b32 s42, 0x1ffffff
    s_mov_b32 s43, 0x1fffffff
    v_cndmask_b32_e64 v165, v9, 0, s[42:43]
    s_mov_b32 s40, 0x3ffffff
    s_mov_b32 s41, 0x3fffffff
    v_cndmask_b32_e64 v166, v9, 0, s[40:41]
    s_mov_b32 s42, 0x7ffffff
    s_mov_b32 s43, 0x7fffffff
    v_cndmask_b32_e64 v167, v9, 0, s[42:43]
md_60:
    s_waitcnt vmcnt(0)
    s_nop 1
    v_mfma_f32_32x32x16_bf16 v[32:47], v[136:139], v[96:99], v[152:167]
    s_add_u32 s33, s33, 0xfffff780
    s_add_u32 s34, s34, 1
    s_nop 15
    v_sub_f32 v32, v32, v7
    v_sub_f32 v33, v33, v7
    v_sub_f32 v34, v34, v7
    v_sub_f32 v35, v35, v7
    v_sub_f32 v36, v36, v7
    v_sub_f32 v37, v37, v7
    v_sub_f32 v38, v38, v7
    v_sub_f32 v39, v39, v7
    v_sub_f32 v40, v40, v7
    v_sub_f32 v41, v41, v7
    v_sub_f32 v42, v42, v7
    v_sub_f32 v43, v43, v7
    v_sub_f32 v44, v44, v7
    v_sub_f32 v45, v45, v7
    v_sub_f32 v46, v46, v7
    v_sub_f32 v47, v47, v7
    v_exp_f32 v32, v32
    v_exp_f32 v33, v33
    v_exp_f32 v34, v34
    v_exp_f32 v35, v35
    v_exp_f32 v36, v36
    v_exp_f32 v37, v37
    v_exp_f32 v38, v38
    v_exp_f32 v39, v39
    v_exp_f32 v40, v40
    v_exp_f32 v41, v41
    v_exp_f32 v42, v42
    v_exp_f32 v43, v43
    v_exp_f32 v44, v44
    v_exp_f32 v45, v45
    v_exp_f32 v46, v46
    v_exp_f32 v47, v47
    s_nop 2
    v_smfmac_f32_32x32x32_bf16 v[104:119], v[140:143], v[32:39], v10
    v_smfmac_f32_32x32x32_bf16 v[104:119], v[144:147], v[40:47], v10
    s_cmp_lt_u32 s34, s30
    s_nop 15
    s_cbranch_scc1 sp2_54
    s_branch L_b_ok0
L_b_slow1:
    s_waitcnt vmcnt(0) lgkmcnt(0)
    v_mov_b32 v9, 0xfe967699
    v_mov_b32 v7, v9
    s_mov_b32 s33, s29
    s_mov_b32 s34, 0
sp1_61:
    buffer_load_dwordx4 v[136:139], v2, s[12:15], s33 offen sc1
    s_cmp_eq_u32 s34, 0
    s_cbranch_scc1 m0_63
    s_cmp_eq_u32 s34, 8
    s_cbranch_scc1 m8_64
    v_mov_b32 v152, 0
    v_mov_b32 v153, 0
    v_mov_b32 v154, 0
    v_mov_b32 v155, 0
    v_mov_b32 v156, 0
    v_mov_b32 v157, 0
    v_mov_b32 v158, 0
    v_mov_b32 v159, 0
    v_mov_b32 v160, 0
    v_mov_b32 v161, 0
    v_mov_b32 v162, 0
    v_mov_b32 v163, 0
    v_mov_b32 v164, 0
    v_mov_b32 v165, 0
    v_mov_b32 v166, 0
    v_mov_b32 v167, 0
    s_branch md_65
m0_63:
    s_mov_b32 s40, 0x0
    s_mov_b32 s41, 0xf
    v_cndmask_b32_e64 v152, 0, v9, s[40:41]
    s_mov_b32 s42, 0x1
    s_mov_b32 s43, 0x1f
    v_cndmask_b32_e64 v153, 0, v9, s[42:43]
    s_mov_b32 s40, 0x3
    s_mov_b32 s41, 0x3f
    v_cndmask_b32_e64 v154, 0, v9, s[40:41]
    s_mov_b32 s42, 0x7
    s_mov_b32 s43, 0x7f
    v_cndmask_b32_e64 v155, 0, v9, s[42:43]
    s_mov_b32 s40, 0xff
    s_mov_b32 s41, 0xfff
    v_cndmask_b32_e64 v156, 0, v9, s[40:41]
    s_mov_b32 s42, 0x1ff
    s_mov_b32 s43, 0x1fff
    v_cndmask_b32_e64 v157, 0, v9, s[42:43]
    s_mov_b32 s40, 0x3ff
    s_mov_b32 s41, 0x3fff
    v_cndmask_b32_e64 v158, 0, v9, s[40:41]
    s_mov_b32 s42, 0x7ff
    s_mov_b32 s43, 0x7fff
    v_cndmask_b32_e64 v159, 0, v9, s[42:43]
    s_mov_b32 s40, 0xffff
    s_mov_b32 s41, 0xfffff
    v_cndmask_b32_e64 v160, 0, v9, s[40:41]
    s_mov_b32 s42, 0x1ffff
    s_mov_b32 s43, 0x1fffff
    v_cndmask_b32_e64 v161, 0, v9, s[42:43]
    s_mov_b32 s40, 0x3ffff
    s_mov_b32 s41, 0x3fffff
    v_cndmask_b32_e64 v162, 0, v9, s[40:41]
    s_mov_b32 s42, 0x7ffff
    s_mov_b32 s43, 0x7fffff
    v_cndmask_b32_e64 v163, 0, v9, s[42:43]
    s_mov_b32 s40, 0xffffff
    s_mov_b32 s41, 0xfffffff
    v_cndmask_b32_e64 v164, 0, v9, s[40:41]
    s_mov_b32 s42, 0x1ffffff
    s_mov_b32 s43, 0x1fffffff
    v_cndmask_b32_e64 v165, 0, v9, s[42:43]
    s_mov_b32 s40, 0x3ffffff
    s_mov_b32 s41, 0x3fffffff
    v_cndmask_b32_e64 v166, 0, v9, s[40:41]
    s_mov_b32 s42, 0x7ffffff
    s_mov_b32 s43, 0x7fffffff
    v_cndmask_b32_e64 v167, 0, v9, s[42:43]
    s_branch md_65
m8_64:
    s_mov_b32 s40, 0x0
    s_mov_b32 s41, 0xf
    v_cndmask_b32_e64 v152, v9, 0, s[40:41]
    s_mov_b32 s42, 0x1
    s_mov_b32 s43, 0x1f
    v_cndmask_b32_e64 v153, v9, 0, s[42:43]
    s_mov_b32 s40, 0x3
    s_mov_b32 s41, 0x3f
    v_cndmask_b32_e64 v154, v9, 0, s[40:41]
    s_mov_b32 s42, 0x7
    s_mov_b32 s43, 0x7f
    v_cndmask_b32_e64 v155, v9, 0, s[42:43]
    s_mov_b32 s40, 0xff
    s_mov_b32 s41, 0xfff
    v_cndmask_b32_e64 v156, v9, 0, s[40:41]
    s_mov_b32 s42, 0x1ff
    s_mov_b32 s43, 0x1fff
    v_cndmask_b32_e64 v157, v9, 0, s[42:43]
    s_mov_b32 s40, 0x3ff
    s_mov_b32 s41, 0x3fff
    v_cndmask_b32_e64 v158, v9, 0, s[40:41]
    s_mov_b32 s42, 0x7ff
    s_mov_b32 s43, 0x7fff
    v_cndmask_b32_e64 v159, v9, 0, s[42:43]
    s_mov_b32 s40, 0xffff
    s_mov_b32 s41, 0xfffff
    v_cndmask_b32_e64 v160, v9, 0, s[40:41]
    s_mov_b32 s42, 0x1ffff
    s_mov_b32 s43, 0x1fffff
    v_cndmask_b32_e64 v161, v9, 0, s[42:43]
    s_mov_b32 s40, 0x3ffff
    s_mov_b32 s41, 0x3fffff
    v_cndmask_b32_e64 v162, v9, 0, s[40:41]
    s_mov_b32 s42, 0x7ffff
    s_mov_b32 s43, 0x7fffff
    v_cndmask_b32_e64 v163, v9, 0, s[42:43]
    s_mov_b32 s40, 0xffffff
    s_mov_b32 s41, 0xfffffff
    v_cndmask_b32_e64 v164, v9, 0, s[40:41]
    s_mov_b32 s42, 0x1ffffff
    s_mov_b32 s43, 0x1fffffff
    v_cndmask_b32_e64 v165, v9, 0, s[42:43]
    s_mov_b32 s40, 0x3ffffff
    s_mov_b32 s41, 0x3fffffff
    v_cndmask_b32_e64 v166, v9, 0, s[40:41]
    s_mov_b32 s42, 0x7ffffff
    s_mov_b32 s43, 0x7fffffff
    v_cndmask_b32_e64 v167, v9, 0, s[42:43]
md_65:
    s_waitcnt vmcnt(0)
    s_nop 1
    v_mfma_f32_32x32x16_bf16 v[32:47], v[136:139], v[100:103], v[152:167]
    s_add_u32 s33, s33, 0xfffff780
    s_add_u32 s34, s34, 1
    s_nop 15
    v_max3_f32 v7, v7, v32, v33
    v_max3_f32 v7, v7, v34, v35
    v_max3_f32 v7, v7, v36, v37
    v_max3_f32 v7, v7, v38, v39
    v_max3_f32 v7, v7, v40, v41
    v_max3_f32 v7, v7, v42, v43
    v_max3_f32 v7, v7, v44, v45
    v_max3_f32 v7, v7, v46, v47
    s_cmp_lt_u32 s34, s30
    s_cbranch_scc1 sp1_61
    v_mov_b32 v8, v7
    s_nop 1
    v_permlane32_swap_b32 v7, v8
    v_max_f32 v7, v7, v8
    v_mov_b32 v120, 0
    v_mov_b32 v121, 0
    v_mov_b32 v122, 0
    v_mov_b32 v123, 0
    v_mov_b32 v124, 0
    v_mov_b32 v125, 0
    v_mov_b32 v126, 0
    v_mov_b32 v127, 0
    v_mov_b32 v128, 0
    v_mov_b32 v129, 0
    v_mov_b32 v130, 0
    v_mov_b32 v131, 0
    v_mov_b32 v132, 0
    v_mov_b32 v133, 0
    v_mov_b32 v134, 0
    v_mov_b32 v135, 0
    s_mov_b32 s33, s29
    s_mov_b32 s34, 0
sp2_62:
    buffer_load_dwordx4 v[136:139], v2, s[12:15], s33 offen sc1
    buffer_load_dwordx4 v[140:143], v3, s[12:15], s33 offen sc1
    buffer_load_dwordx4 v[144:147], v0, s[12:15], s33 offen sc1
    s_cmp_eq_u32 s34, 0
    s_cbranch_scc1 m0_66
    s_cmp_eq_u32 s34, 8
    s_cbranch_scc1 m8_67
    v_mov_b32 v152, 0
    v_mov_b32 v153, 0
    v_mov_b32 v154, 0
    v_mov_b32 v155, 0
    v_mov_b32 v156, 0
    v_mov_b32 v157, 0
    v_mov_b32 v158, 0
    v_mov_b32 v159, 0
    v_mov_b32 v160, 0
    v_mov_b32 v161, 0
    v_mov_b32 v162, 0
    v_mov_b32 v163, 0
    v_mov_b32 v164, 0
    v_mov_b32 v165, 0
    v_mov_b32 v166, 0
    v_mov_b32 v167, 0
    s_branch md_68
m0_66:
    s_mov_b32 s40, 0x0
    s_mov_b32 s41, 0xf
    v_cndmask_b32_e64 v152, 0, v9, s[40:41]
    s_mov_b32 s42, 0x1
    s_mov_b32 s43, 0x1f
    v_cndmask_b32_e64 v153, 0, v9, s[42:43]
    s_mov_b32 s40, 0x3
    s_mov_b32 s41, 0x3f
    v_cndmask_b32_e64 v154, 0, v9, s[40:41]
    s_mov_b32 s42, 0x7
    s_mov_b32 s43, 0x7f
    v_cndmask_b32_e64 v155, 0, v9, s[42:43]
    s_mov_b32 s40, 0xff
    s_mov_b32 s41, 0xfff
    v_cndmask_b32_e64 v156, 0, v9, s[40:41]
    s_mov_b32 s42, 0x1ff
    s_mov_b32 s43, 0x1fff
    v_cndmask_b32_e64 v157, 0, v9, s[42:43]
    s_mov_b32 s40, 0x3ff
    s_mov_b32 s41, 0x3fff
    v_cndmask_b32_e64 v158, 0, v9, s[40:41]
    s_mov_b32 s42, 0x7ff
    s_mov_b32 s43, 0x7fff
    v_cndmask_b32_e64 v159, 0, v9, s[42:43]
    s_mov_b32 s40, 0xffff
    s_mov_b32 s41, 0xfffff
    v_cndmask_b32_e64 v160, 0, v9, s[40:41]
    s_mov_b32 s42, 0x1ffff
    s_mov_b32 s43, 0x1fffff
    v_cndmask_b32_e64 v161, 0, v9, s[42:43]
    s_mov_b32 s40, 0x3ffff
    s_mov_b32 s41, 0x3fffff
    v_cndmask_b32_e64 v162, 0, v9, s[40:41]
    s_mov_b32 s42, 0x7ffff
    s_mov_b32 s43, 0x7fffff
    v_cndmask_b32_e64 v163, 0, v9, s[42:43]
    s_mov_b32 s40, 0xffffff
    s_mov_b32 s41, 0xfffffff
    v_cndmask_b32_e64 v164, 0, v9, s[40:41]
    s_mov_b32 s42, 0x1ffffff
    s_mov_b32 s43, 0x1fffffff
    v_cndmask_b32_e64 v165, 0, v9, s[42:43]
    s_mov_b32 s40, 0x3ffffff
    s_mov_b32 s41, 0x3fffffff
    v_cndmask_b32_e64 v166, 0, v9, s[40:41]
    s_mov_b32 s42, 0x7ffffff
    s_mov_b32 s43, 0x7fffffff
    v_cndmask_b32_e64 v167, 0, v9, s[42:43]
    s_branch md_68
m8_67:
    s_mov_b32 s40, 0x0
    s_mov_b32 s41, 0xf
    v_cndmask_b32_e64 v152, v9, 0, s[40:41]
    s_mov_b32 s42, 0x1
    s_mov_b32 s43, 0x1f
    v_cndmask_b32_e64 v153, v9, 0, s[42:43]
    s_mov_b32 s40, 0x3
    s_mov_b32 s41, 0x3f
    v_cndmask_b32_e64 v154, v9, 0, s[40:41]
    s_mov_b32 s42, 0x7
    s_mov_b32 s43, 0x7f
    v_cndmask_b32_e64 v155, v9, 0, s[42:43]
    s_mov_b32 s40, 0xff
    s_mov_b32 s41, 0xfff
    v_cndmask_b32_e64 v156, v9, 0, s[40:41]
    s_mov_b32 s42, 0x1ff
    s_mov_b32 s43, 0x1fff
    v_cndmask_b32_e64 v157, v9, 0, s[42:43]
    s_mov_b32 s40, 0x3ff
    s_mov_b32 s41, 0x3fff
    v_cndmask_b32_e64 v158, v9, 0, s[40:41]
    s_mov_b32 s42, 0x7ff
    s_mov_b32 s43, 0x7fff
    v_cndmask_b32_e64 v159, v9, 0, s[42:43]
    s_mov_b32 s40, 0xffff
    s_mov_b32 s41, 0xfffff
    v_cndmask_b32_e64 v160, v9, 0, s[40:41]
    s_mov_b32 s42, 0x1ffff
    s_mov_b32 s43, 0x1fffff
    v_cndmask_b32_e64 v161, v9, 0, s[42:43]
    s_mov_b32 s40, 0x3ffff
    s_mov_b32 s41, 0x3fffff
    v_cndmask_b32_e64 v162, v9, 0, s[40:41]
    s_mov_b32 s42, 0x7ffff
    s_mov_b32 s43, 0x7fffff
    v_cndmask_b32_e64 v163, v9, 0, s[42:43]
    s_mov_b32 s40, 0xffffff
    s_mov_b32 s41, 0xfffffff
    v_cndmask_b32_e64 v164, v9, 0, s[40:41]
    s_mov_b32 s42, 0x1ffffff
    s_mov_b32 s43, 0x1fffffff
    v_cndmask_b32_e64 v165, v9, 0, s[42:43]
    s_mov_b32 s40, 0x3ffffff
    s_mov_b32 s41, 0x3fffffff
    v_cndmask_b32_e64 v166, v9, 0, s[40:41]
    s_mov_b32 s42, 0x7ffffff
    s_mov_b32 s43, 0x7fffffff
    v_cndmask_b32_e64 v167, v9, 0, s[42:43]
md_68:
    s_waitcnt vmcnt(0)
    s_nop 1
    v_mfma_f32_32x32x16_bf16 v[32:47], v[136:139], v[100:103], v[152:167]
    s_add_u32 s33, s33, 0xfffff780
    s_add_u32 s34, s34, 1
    s_nop 15
    v_sub_f32 v32, v32, v7
    v_sub_f32 v33, v33, v7
    v_sub_f32 v34, v34, v7
    v_sub_f32 v35, v35, v7
    v_sub_f32 v36, v36, v7
    v_sub_f32 v37, v37, v7
    v_sub_f32 v38, v38, v7
    v_sub_f32 v39, v39, v7
    v_sub_f32 v40, v40, v7
    v_sub_f32 v41, v41, v7
    v_sub_f32 v42, v42, v7
    v_sub_f32 v43, v43, v7
    v_sub_f32 v44, v44, v7
    v_sub_f32 v45, v45, v7
    v_sub_f32 v46, v46, v7
    v_sub_f32 v47, v47, v7
    v_exp_f32 v32, v32
    v_exp_f32 v33, v33
    v_exp_f32 v34, v34
    v_exp_f32 v35, v35
    v_exp_f32 v36, v36
    v_exp_f32 v37, v37
    v_exp_f32 v38, v38
    v_exp_f32 v39, v39
    v_exp_f32 v40, v40
    v_exp_f32 v41, v41
    v_exp_f32 v42, v42
    v_exp_f32 v43, v43
    v_exp_f32 v44, v44
    v_exp_f32 v45, v45
    v_exp_f32 v46, v46
    v_exp_f32 v47, v47
    s_nop 2
    v_smfmac_f32_32x32x32_bf16 v[120:135], v[140:143], v[32:39], v10
    v_smfmac_f32_32x32x32_bf16 v[120:135], v[144:147], v[40:47], v10
    s_cmp_lt_u32 s34, s30
    s_nop 15
    s_cbranch_scc1 sp2_62
    s_branch L_b_ok1
L_ateam:
    v_lshrrev_b32 v4, 3, v1
    v_lshlrev_b32 v4, 10, v4
    v_lshrrev_b32 v5, 2, v1
    v_and_b32 v5, 4, v5
    v_xor_b32 v5, v5, v1
    v_and_b32 v5, 7, v5
    v_lshl_add_u32 v8, v5, 4, v4
    s_lshl_b32 s34, s16, 14
    s_lshl_b32 s24, s17, 7
    s_add_u32 s34, s34, s24
    s_lshl_b32 s35, s16, 11
    s_add_u32 s35, s35, 65536
    s_waitcnt lgkmcnt(0)
    s_mov_b32 s4, s44
    s_and_b32 s5, s45, 0xffff
    s_mov_b32 s6, 0x200000
    s_mov_b32 s7, 0x00020000
    s_mov_b32 s8, s46
    s_and_b32 s9, s47, 0xffff
    s_mov_b32 s10, 0x80000
    s_mov_b32 s11, 0x00020000
    s_cmp_lg_u32 s16, 3
    s_cbranch_scc1 L_nocpf
    s_getpc_b64 s[38:39]
L_pc:
    s_sub_u32 s38, s38, L_pc-gated_mix__grouped_kv_mqa__sliding_block__prompt_kernel
    s_subb_u32 s39, s39, 0
    s_lshr_b32 s24, s2, 3
    v_lshlrev_b32 v4, 5, v1
    v_add_u32 v4, s24, v4
    v_lshlrev_b32 v4, 7, v4
    v_cmp_gt_u32 vcc, L_code_end-gated_mix__grouped_kv_mqa__sliding_block__prompt_kernel, v4
    v_mov_b32 v6, s39
    v_add_co_u32 v4, s[40:41], s38, v4
    s_nop 1
    v_addc_co_u32 v5, s[40:41], 0, v6, s[40:41]
    s_mov_b64 exec, vcc
    global_load_dword v254, v[4:5], off
    s_mov_b64 exec, -1
L_nocpf:
    s_and_b32 s54, s18, 7
    s_mov_b32 s12, s66
    s_and_b32 s13, s67, 0xffff
    s_mov_b32 s14, 0x1000000
    s_mov_b32 s15, 0x00020000
    s_and_b32 s55, s16, 1
    s_lshl_b32 s25, s55, 12
    v_and_b32 v4, 31, v1
    v_lshrrev_b32 v5, 5, v1
    v_bfe_u32 v6, v1, 1, 3
    v_xor_b32 v5, v5, v6
    v_lshl_add_u32 v4, v4, 7, s25
    v_xor_b32 v6, 0, v5
    v_lshl_add_u32 v9, v6, 4, v4
    v_xor_b32 v6, 2, v5
    v_lshl_add_u32 v10, v6, 4, v4
    v_xor_b32 v6, 4, v5
    v_lshl_add_u32 v11, v6, 4, v4
    v_xor_b32 v6, 6, v5
    v_lshl_add_u32 v12, v6, 4, v4
    s_lshr_b32 s28, s16, 1
    s_mov_b32 s25, 65536
    v_lshrrev_b32 v4, 5, v1
    v_bfe_u32 v5, v1, 2, 2
    v_mad_u32_u24 v4, v4, 8, v5
    v_and_b32 v5, 3, v1
    v_lshlrev_b32 v5, 3, v5
    v_lshl_add_u32 v4, v4, 7, v5
    v_bfe_u32 v5, v1, 4, 1
    v_lshl_add_u32 v4, v5, 5, v4
    v_bfe_u32 v5, v1, 3, 1
    v_xor_b32 v5, s28, v5
    v_lshl_add_u32 v4, v5, 6, v4
    v_add_u32 v13, s25, v4
    v_and_b32 v4, 31, v1
    v_lshrrev_b32 v5, 5, v1
    v_lshlrev_b32 v5, 8, v5
    v_lshl_add_u32 v3, v4, 4, v5
    v_add_u32 v3, 1024, v3
    v_mov_b32 v5, 0x40000000
    v_cmp_gt_u32 s[38:39], 16, v4
    v_and_b32 v4, 27, v4
    v_mov_b32 v6, 2048
    v_cndmask_b32_e64 v3, v5, v3, s[38:39]
    v_cmp_eq_u32 s[38:39], 16, v4
    v_add_u32 v0, 512, v3
    s_nop 0
    v_cndmask_b32_e64 v3, v3, v6, s[38:39]
    v_cndmask_b32_e64 v0, v0, v6, s[38:39]
    v_pk_mov_b32 v[112:113], 0, 0
    v_pk_mov_b32 v[114:115], 0, 0
    v_pk_mov_b32 v[116:117], 0, 0
    v_pk_mov_b32 v[118:119], 0, 0
    v_pk_mov_b32 v[120:121], 0, 0
    v_pk_mov_b32 v[128:129], 0, 0
    v_pk_mov_b32 v[130:131], 0, 0
    v_pk_mov_b32 v[132:133], 0, 0
    v_pk_mov_b32 v[134:135], 0, 0
    v_pk_mov_b32 v[136:137], 0, 0
    v_pk_mov_b32 v[144:145], 0, 0
    v_pk_mov_b32 v[146:147], 0, 0
    v_pk_mov_b32 v[148:149], 0, 0
    v_pk_mov_b32 v[150:151], 0, 0
    v_pk_mov_b32 v[152:153], 0, 0
    v_pk_mov_b32 v[160:161], 0, 0
    v_pk_mov_b32 v[162:163], 0, 0
    v_pk_mov_b32 v[164:165], 0, 0
    v_pk_mov_b32 v[166:167], 0, 0
    v_pk_mov_b32 v[168:169], 0, 0
    s_lshl_b32 s25, s37, 13
    s_add_u32 m0, s27, s25
    s_lshl_b32 s25, s37, 7
    s_add_u32 s25, s25, s33
    buffer_load_dwordx4 v7, s[4:7], s25 offen lds
    s_add_u32 s37, s37, 1
    s_and_b32 s37, s37, 7
    s_lshl_b32 s25, s54, 13
    s_add_u32 m0, s35, s25
    s_lshl_b32 s25, s54, 16
    s_add_u32 s25, s25, s34
    buffer_load_dwordx4 v8, s[8:11], s25 offen lds
    s_add_u32 m0, m0, 1024
    s_add_u32 s25, s25, 8192
    buffer_load_dwordx4 v8, s[8:11], s25 offen lds
    s_add_u32 s54, s54, 1
    s_and_b32 s54, s54, 7
    s_lshl_b32 s25, s37, 13
    s_add_u32 m0, s27, s25
    s_lshl_b32 s25, s37, 7
    s_add_u32 s25, s25, s33
    buffer_load_dwordx4 v7, s[4:7], s25 offen lds
    s_add_u32 s37, s37, 1
    s_and_b32 s37, s37, 7
    s_lshl_b32 s25, s54, 13
    s_add_u32 m0, s35, s25
    s_lshl_b32 s25, s54, 16
    s_add_u32 s25, s25, s34
    buffer_load_dwordx4 v8, s[8:11], s25 offen lds
    s_add_u32 m0, m0, 1024
    s_add_u32 s25, s25, 8192
    buffer_load_dwordx4 v8, s[8:11], s25 offen lds
    s_add_u32 s54, s54, 1
    s_and_b32 s54, s54, 7
    s_lshl_b32 s25, s37, 13
    s_add_u32 m0, s27, s25
    s_lshl_b32 s25, s37, 7
    s_add_u32 s25, s25, s33
    buffer_load_dwordx4 v7, s[4:7], s25 offen lds
    s_add_u32 s37, s37, 1
    s_and_b32 s37, s37, 7
    s_lshl_b32 s25, s54, 13
    s_add_u32 m0, s35, s25
    s_lshl_b32 s25, s54, 16
    s_add_u32 s25, s25, s34
    buffer_load_dwordx4 v8, s[8:11], s25 offen lds
    s_add_u32 m0, m0, 1024
    s_add_u32 s25, s25, 8192
    buffer_load_dwordx4 v8, s[8:11], s25 offen lds
    s_add_u32 s54, s54, 1
    s_and_b32 s54, s54, 7
    s_lshl_b32 s25, s37, 13
    s_add_u32 m0, s27, s25
    s_lshl_b32 s25, s37, 7
    s_add_u32 s25, s25, s33
    buffer_load_dwordx4 v7, s[4:7], s25 offen lds
    s_add_u32 s37, s37, 1
    s_and_b32 s37, s37, 7
    s_lshl_b32 s25, s54, 13
    s_add_u32 m0, s35, s25
    s_lshl_b32 s25, s54, 16
    s_add_u32 s25, s25, s34
    buffer_load_dwordx4 v8, s[8:11], s25 offen lds
    s_add_u32 m0, m0, 1024
    s_add_u32 s25, s25, 8192
    buffer_load_dwordx4 v8, s[8:11], s25 offen lds
    s_add_u32 s54, s54, 1
    s_and_b32 s54, s54, 7
    s_lshl_b32 s25, s37, 13
    s_add_u32 m0, s27, s25
    s_lshl_b32 s25, s37, 7
    s_add_u32 s25, s25, s33
    buffer_load_dwordx4 v7, s[4:7], s25 offen lds
    s_add_u32 s37, s37, 1
    s_and_b32 s37, s37, 7
    s_lshl_b32 s25, s54, 13
    s_add_u32 m0, s35, s25
    s_lshl_b32 s25, s54, 16
    s_add_u32 s25, s25, s34
    buffer_load_dwordx4 v8, s[8:11], s25 offen lds
    s_add_u32 m0, m0, 1024
    s_add_u32 s25, s25, 8192
    buffer_load_dwordx4 v8, s[8:11], s25 offen lds
    s_add_u32 s54, s54, 1
    s_and_b32 s54, s54, 7
    s_lshl_b32 s25, s37, 13
    s_add_u32 m0, s27, s25
    s_lshl_b32 s25, s37, 7
    s_add_u32 s25, s25, s33
    buffer_load_dwordx4 v7, s[4:7], s25 offen lds
    s_add_u32 s37, s37, 1
    s_and_b32 s37, s37, 7
    s_lshl_b32 s25, s54, 13
    s_add_u32 m0, s35, s25
    s_lshl_b32 s25, s54, 16
    s_add_u32 s25, s25, s34
    buffer_load_dwordx4 v8, s[8:11], s25 offen lds
    s_add_u32 m0, m0, 1024
    s_add_u32 s25, s25, 8192
    buffer_load_dwordx4 v8, s[8:11], s25 offen lds
    s_add_u32 s54, s54, 1
    s_and_b32 s54, s54, 7
    s_lshl_b32 s25, s37, 13
    s_add_u32 m0, s27, s25
    s_lshl_b32 s25, s37, 7
    s_add_u32 s25, s25, s33
    buffer_load_dwordx4 v7, s[4:7], s25 offen lds
    s_add_u32 s37, s37, 1
    s_and_b32 s37, s37, 7
    s_lshl_b32 s25, s54, 13
    s_add_u32 m0, s35, s25
    s_lshl_b32 s25, s54, 16
    s_add_u32 s25, s25, s34
    buffer_load_dwordx4 v8, s[8:11], s25 offen lds
    s_add_u32 m0, m0, 1024
    s_add_u32 s25, s25, 8192
    buffer_load_dwordx4 v8, s[8:11], s25 offen lds
    s_add_u32 s54, s54, 1
    s_and_b32 s54, s54, 7
    s_lshl_b32 s25, s37, 13
    s_add_u32 m0, s27, s25
    s_lshl_b32 s25, s37, 7
    s_add_u32 s25, s25, s33
    buffer_load_dwordx4 v7, s[4:7], s25 offen lds
    s_lshl_b32 s25, s54, 13
    s_add_u32 m0, s35, s25
    s_lshl_b32 s25, s54, 16
    s_add_u32 s25, s25, s34
    buffer_load_dwordx4 v8, s[8:11], s25 offen lds
    s_add_u32 m0, m0, 1024
    s_add_u32 s25, s25, 8192
    buffer_load_dwordx4 v8, s[8:11], s25 offen lds
    s_waitcnt vmcnt(0)
    v_mov_b32 v4, 156692
    v_mov_b32 v5, 1
    s_mov_b64 exec, 1
    ds_add_u32 v4, v5
    s_mov_b64 exec, -1
    v_mov_b32 v4, 156692
    s_mov_b32 s36, 400000
tw_1:
    ds_read_b32 v5, v4
    s_waitcnt lgkmcnt(0)
    v_readfirstlane_b32 s24, v5
    s_nop 1
    s_cmp_ge_u32 s24, 8
    s_cbranch_scc1 twd_2
    s_sub_u32 s36, s36, 1
    s_cbranch_scc1 twd_2
    s_sleep 1
    s_branch tw_1
twd_2:
    ds_read_b64_tr_b16 v[200:201], v13 offset:0
    ds_read_b64_tr_b16 v[202:203], v13 offset:512
    ds_read_b128 v[204:207], v9 offset:0
    ds_read_b64_tr_b16 v[208:209], v13 offset:2048
    ds_read_b64_tr_b16 v[210:211], v13 offset:2560
    ds_read_b128 v[212:215], v10 offset:0
    ds_read_b64_tr_b16 v[216:217], v13 offset:4096
    ds_read_b64_tr_b16 v[218:219], v13 offset:4608
    ds_read_b128 v[220:223], v11 offset:0
    ds_read_b64_tr_b16 v[224:225], v13 offset:6144
    ds_read_b64_tr_b16 v[226:227], v13 offset:6656
    ds_read_b128 v[228:231], v12 offset:0
    s_waitcnt lgkmcnt(9)
    v_mfma_f32_32x32x16_bf16 v[32:47], v[200:203], v[204:207], 0
    ds_read_b64_tr_b16 v[200:201], v13 offset:8192
    ds_read_b64_tr_b16 v[202:203], v13 offset:8704
    ds_read_b128 v[204:207], v9 offset:8192
    s_waitcnt lgkmcnt(9)
    v_mfma_f32_32x32x16_bf16 v[32:47], v[208:211], v[212:215], v[32:47]
    ds_read_b64_tr_b16 v[208:209], v13 offset:10240
    ds_read_b64_tr_b16 v[210:211], v13 offset:10752
    ds_read_b128 v[212:215], v10 offset:8192
    s_waitcnt lgkmcnt(9)
    v_mfma_f32_32x32x16_bf16 v[32:47], v[216:219], v[220:223], v[32:47]
    ds_read_b64_tr_b16 v[216:217], v13 offset:12288
    ds_read_b64_tr_b16 v[218:219], v13 offset:12800
    ds_read_b128 v[220:223], v11 offset:8192
    s_waitcnt lgkmcnt(9)
    v_mfma_f32_32x32x16_bf16 v[32:47], v[224:227], v[228:231], v[32:47]
    ds_read_b64_tr_b16 v[224:225], v13 offset:14336
    ds_read_b64_tr_b16 v[226:227], v13 offset:14848
    ds_read_b128 v[228:231], v12 offset:8192
    s_waitcnt lgkmcnt(9)
    v_mfma_f32_32x32x16_bf16 v[32:47], v[200:203], v[204:207], v[32:47]
    ds_read_b64_tr_b16 v[200:201], v13 offset:16384
    ds_read_b64_tr_b16 v[202:203], v13 offset:16896
    ds_read_b128 v[204:207], v9 offset:16384
    s_waitcnt lgkmcnt(9)
    v_mfma_f32_32x32x16_bf16 v[32:47], v[208:211], v[212:215], v[32:47]
    ds_read_b64_tr_b16 v[208:209], v13 offset:18432
    ds_read_b64_tr_b16 v[210:211], v13 offset:18944
    ds_read_b128 v[212:215], v10 offset:16384
    s_waitcnt lgkmcnt(9)
    v_mfma_f32_32x32x16_bf16 v[32:47], v[216:219], v[220:223], v[32:47]
    ds_read_b64_tr_b16 v[216:217], v13 offset:20480
    ds_read_b64_tr_b16 v[218:219], v13 offset:20992
    ds_read_b128 v[220:223], v11 offset:16384
    s_waitcnt lgkmcnt(9)
    v_mfma_f32_32x32x16_bf16 v[32:47], v[224:227], v[228:231], v[32:47]
    ds_read_b64_tr_b16 v[224:225], v13 offset:22528
    ds_read_b64_tr_b16 v[226:227], v13 offset:23040
    ds_read_b128 v[228:231], v12 offset:16384
    s_waitcnt lgkmcnt(9)
    v_mfma_f32_32x32x16_bf16 v[32:47], v[200:203], v[204:207], v[32:47]
    ds_read_b64_tr_b16 v[200:201], v13 offset:24576
    ds_read_b64_tr_b16 v[202:203], v13 offset:25088
    ds_read_b128 v[204:207], v9 offset:24576
    s_waitcnt lgkmcnt(9)
    v_mfma_f32_32x32x16_bf16 v[32:47], v[208:211], v[212:215], v[32:47]
    ds_read_b64_tr_b16 v[208:209], v13 offset:26624
    ds_read_b64_tr_b16 v[210:211], v13 offset:27136
    ds_read_b128 v[212:215], v10 offset:24576
    s_waitcnt lgkmcnt(9)
    v_mfma_f32_32x32x16_bf16 v[32:47], v[216:219], v[220:223], v[32:47]
    ds_read_b64_tr_b16 v[216:217], v13 offset:28672
    ds_read_b64_tr_b16 v[218:219], v13 offset:29184
    ds_read_b128 v[220:223], v11 offset:24576
    s_waitcnt lgkmcnt(9)
    v_mfma_f32_32x32x16_bf16 v[32:47], v[224:227], v[228:231], v[32:47]
    ds_read_b64_tr_b16 v[224:225], v13 offset:30720
    ds_read_b64_tr_b16 v[226:227], v13 offset:31232
    ds_read_b128 v[228:231], v12 offset:24576
    s_waitcnt lgkmcnt(9)
    v_mfma_f32_32x32x16_bf16 v[32:47], v[200:203], v[204:207], v[32:47]
    ds_read_b64_tr_b16 v[200:201], v13 offset:32768
    ds_read_b64_tr_b16 v[202:203], v13 offset:33280
    ds_read_b128 v[204:207], v9 offset:32768
    s_waitcnt lgkmcnt(9)
    v_mfma_f32_32x32x16_bf16 v[32:47], v[208:211], v[212:215], v[32:47]
    ds_read_b64_tr_b16 v[208:209], v13 offset:34816
    ds_read_b64_tr_b16 v[210:211], v13 offset:35328
    ds_read_b128 v[212:215], v10 offset:32768
    s_waitcnt lgkmcnt(9)
    v_mfma_f32_32x32x16_bf16 v[32:47], v[216:219], v[220:223], v[32:47]
    ds_read_b64_tr_b16 v[216:217], v13 offset:36864
    ds_read_b64_tr_b16 v[218:219], v13 offset:37376
    ds_read_b128 v[220:223], v11 offset:32768
    s_waitcnt lgkmcnt(9)
    v_mfma_f32_32x32x16_bf16 v[32:47], v[224:227], v[228:231], v[32:47]
    ds_read_b64_tr_b16 v[224:225], v13 offset:38912
    ds_read_b64_tr_b16 v[226:227], v13 offset:39424
    ds_read_b128 v[228:231], v12 offset:32768
    s_waitcnt lgkmcnt(9)
    v_mfma_f32_32x32x16_bf16 v[32:47], v[200:203], v[204:207], v[32:47]
    ds_read_b64_tr_b16 v[200:201], v13 offset:40960
    ds_read_b64_tr_b16 v[202:203], v13 offset:41472
    ds_read_b128 v[204:207], v9 offset:40960
    s_waitcnt lgkmcnt(9)
    v_mfma_f32_32x32x16_bf16 v[32:47], v[208:211], v[212:215], v[32:47]
    ds_read_b64_tr_b16 v[208:209], v13 offset:43008
    ds_read_b64_tr_b16 v[210:211], v13 offset:43520
    ds_read_b128 v[212:215], v10 offset:40960
    s_waitcnt lgkmcnt(9)
    v_mfma_f32_32x32x16_bf16 v[32:47], v[216:219], v[220:223], v[32:47]
    ds_read_b64_tr_b16 v[216:217], v13 offset:45056
    ds_read_b64_tr_b16 v[218:219], v13 offset:45568
    ds_read_b128 v[220:223], v11 offset:40960
    s_waitcnt lgkmcnt(9)
    v_mfma_f32_32x32x16_bf16 v[32:47], v[224:227], v[228:231], v[32:47]
    ds_read_b64_tr_b16 v[224:225], v13 offset:47104
    ds_read_b64_tr_b16 v[226:227], v13 offset:47616
    ds_read_b128 v[228:231], v12 offset:40960
    s_waitcnt lgkmcnt(9)
    v_mfma_f32_32x32x16_bf16 v[32:47], v[200:203], v[204:207], v[32:47]
    ds_read_b64_tr_b16 v[200:201], v13 offset:49152
    ds_read_b64_tr_b16 v[202:203], v13 offset:49664
    ds_read_b128 v[204:207], v9 offset:49152
    s_waitcnt lgkmcnt(9)
    v_mfma_f32_32x32x16_bf16 v[32:47], v[208:211], v[212:215], v[32:47]
    ds_read_b64_tr_b16 v[208:209], v13 offset:51200
    ds_read_b64_tr_b16 v[210:211], v13 offset:51712
    ds_read_b128 v[212:215], v10 offset:49152
    s_waitcnt lgkmcnt(9)
    v_mfma_f32_32x32x16_bf16 v[32:47], v[216:219], v[220:223], v[32:47]
    ds_read_b64_tr_b16 v[216:217], v13 offset:53248
    ds_read_b64_tr_b16 v[218:219], v13 offset:53760
    ds_read_b128 v[220:223], v11 offset:49152
    s_waitcnt lgkmcnt(9)
    v_mfma_f32_32x32x16_bf16 v[32:47], v[224:227], v[228:231], v[32:47]
    ds_read_b64_tr_b16 v[224:225], v13 offset:55296
    ds_read_b64_tr_b16 v[226:227], v13 offset:55808
    ds_read_b128 v[228:231], v12 offset:49152
    s_waitcnt lgkmcnt(9)
    v_mfma_f32_32x32x16_bf16 v[32:47], v[200:203], v[204:207], v[32:47]
    ds_read_b64_tr_b16 v[200:201], v13 offset:57344
    ds_read_b64_tr_b16 v[202:203], v13 offset:57856
    ds_read_b128 v[204:207], v9 offset:57344
    s_waitcnt lgkmcnt(9)
    v_mfma_f32_32x32x16_bf16 v[32:47], v[208:211], v[212:215], v[32:47]
    ds_read_b64_tr_b16 v[208:209], v13 offset:59392
    ds_read_b64_tr_b16 v[210:211], v13 offset:59904
    ds_read_b128 v[212:215], v10 offset:57344
    s_waitcnt lgkmcnt(9)
    v_mfma_f32_32x32x16_bf16 v[32:47], v[216:219], v[220:223], v[32:47]
    ds_read_b64_tr_b16 v[216:217], v13 offset:61440
    ds_read_b64_tr_b16 v[218:219], v13 offset:61952
    ds_read_b128 v[220:223], v11 offset:57344
    s_waitcnt lgkmcnt(9)
    v_mfma_f32_32x32x16_bf16 v[32:47], v[224:227], v[228:231], v[32:47]
    ds_read_b64_tr_b16 v[224:225], v13 offset:63488
    ds_read_b64_tr_b16 v[226:227], v13 offset:64000
    ds_read_b128 v[228:231], v12 offset:57344
    s_waitcnt lgkmcnt(9)
    v_mfma_f32_32x32x16_bf16 v[32:47], v[200:203], v[204:207], v[32:47]
    s_waitcnt lgkmcnt(6)
    v_mfma_f32_32x32x16_bf16 v[32:47], v[208:211], v[212:215], v[32:47]
    s_waitcnt lgkmcnt(3)
    v_mfma_f32_32x32x16_bf16 v[32:47], v[216:219], v[220:223], v[32:47]
    s_waitcnt lgkmcnt(0)
    v_mfma_f32_32x32x16_bf16 v[32:47], v[224:227], v[228:231], v[32:47]
    s_mov_b32 s25, 0x3eb8aa3b
    s_lshl_b32 s26, s55, 12
    s_lshl_b32 s27, s28, 11
    s_add_u32 s27, s27, s26
    s_add_u32 s27, s27, 147456
    s_add_u32 s26, s26, 147456
    v_add_u32 v4, s27, v2
    v_add_u32 v6, s26, v2
    s_mul_i32 s37, s28, 69632
    s_add_u32 s54, s37, 69632
    s_mul_i32 s33, s18, 2176
    s_add_u32 s29, s37, s33
    v_pk_mov_b32 v[196:197], 0, 0
    v_pk_mov_b32 v[198:199], 0, 0
    v_mov_b32 v10, 0xdddddddd
    s_nop 0
    v_mul_f32 v32, s25, v32
    v_mul_f32 v33, s25, v33
    v_mul_f32 v34, s25, v34
    v_mul_f32 v35, s25, v35
    v_mul_f32 v36, s25, v36
    v_mul_f32 v37, s25, v37
    v_mul_f32 v38, s25, v38
    v_mul_f32 v39, s25, v39
    v_mul_f32 v40, s25, v40
    v_mul_f32 v41, s25, v41
    v_mul_f32 v42, s25, v42
    v_mul_f32 v43, s25, v43
    v_mul_f32 v44, s25, v44
    v_mul_f32 v45, s25, v45
    v_mul_f32 v46, s25, v46
    v_mul_f32 v47, s25, v47
    v_cvt_pk_bf16_f32 v48, v32, v33
    v_cvt_pk_bf16_f32 v49, v34, v35
    v_cvt_pk_bf16_f32 v50, v36, v37
    v_cvt_pk_bf16_f32 v51, v38, v39
    v_cvt_pk_bf16_f32 v52, v40, v41
    v_cvt_pk_bf16_f32 v53, v42, v43
    v_cvt_pk_bf16_f32 v54, v44, v45
    v_cvt_pk_bf16_f32 v55, v46, v47
    ds_write_b128 v4, v[48:51]
    ds_write_b128 v4, v[52:55] offset:1024
    s_waitcnt lgkmcnt(0)
    v_mov_b32 v4, 156696
    v_mov_b32 v5, 1
    s_mov_b64 exec, 1
    ds_add_u32 v4, v5
    s_mov_b64 exec, -1
    v_mov_b32 v4, 156716
    s_mov_b32 s36, 400000
tw_3:
    ds_read_b32 v5, v4
    s_waitcnt lgkmcnt(0)
    v_readfirstlane_b32 s24, v5
    s_nop 1
    s_cmp_ge_u32 s24, 1
    s_cbranch_scc1 twd_4
    s_sub_u32 s36, s36, 1
    s_cbranch_scc1 twd_4
    s_branch tw_3
twd_4:
    buffer_load_dwordx4 v[200:203], v2, s[12:15], s33 offen sc1
    buffer_load_dwordx4 v[72:75], v2, s[12:15], s29 offen sc1
    buffer_load_dwordx4 v[76:79], v3, s[12:15], s29 offen sc1
    buffer_load_dwordx4 v[80:83], v0, s[12:15], s29 offen sc1
    s_add_u32 s29, s29, 2176
    s_cmp_eq_u32 s29, s54
    s_cselect_b32 s29, s37, s29
    buffer_load_dwordx4 v[84:87], v2, s[12:15], s29 offen sc1
    buffer_load_dwordx4 v[88:91], v3, s[12:15], s29 offen sc1
    buffer_load_dwordx4 v[92:95], v0, s[12:15], s29 offen sc1
    s_add_u32 s29, s29, 2176
    s_cmp_eq_u32 s29, s54
    s_cselect_b32 s29, s37, s29
    buffer_load_dwordx4 v[176:179], v2, s[12:15], s29 offen sc1
    buffer_load_dwordx4 v[180:183], v3, s[12:15], s29 offen sc1
    buffer_load_dwordx4 v[184:187], v0, s[12:15], s29 offen sc1
    s_add_u32 s29, s29, 2176
    s_cmp_eq_u32 s29, s54
    s_cselect_b32 s29, s37, s29
    v_mov_b32 v4, 156696
    s_mov_b32 s36, 400000
tw_5:
    ds_read_b32 v5, v4
    s_waitcnt lgkmcnt(0)
    v_readfirstlane_b32 s24, v5
    s_nop 1
    s_cmp_ge_u32 s24, 4
    s_cbranch_scc1 twd_6
    s_sub_u32 s36, s36, 1
    s_cbranch_scc1 twd_6
    s_sleep 1
    s_branch tw_5
twd_6:
    s_lshl_b32 s25, s28, 11
    v_add_u32 v8, s25, v6
    v_xor_b32 v7, 2048, v8
    ds_read_b128 v[96:99], v7 offset:0
    ds_read_b128 v[100:103], v7 offset:1024
    ds_read_b128 v[104:107], v8 offset:0
    ds_read_b128 v[108:111], v8 offset:1024
    s_mul_i32 s25, s16, 4608
    s_add_u32 s25, s25, 131072
    s_cmp_eq_u32 s16, 3
    s_cselect_b32 s25, 157184, s25
    s_xor_b32 s26, s16, 2
    s_mul_i32 s26, s26, 4608
    s_add_u32 s26, s26, 131072
    s_cmp_eq_u32 s16, 1
    s_cselect_b32 s26, 157184, s26
    v_lshlrev_b32 v14, 2, v1
    v_add_u32 v11, s25, v2
    v_add_u32 v12, s25, v14
    v_add_u32 v13, s26, v2
    v_add_u32 v14, s26, v14
    s_lshl_b32 s35, s18, 1
    s_add_u32 s35, s35, s55
    s_lshl_b32 s35, s35, 6
    s_lshl_b32 s27, s17, 2
    s_add_u32 s35, s35, s27
    s_lshl_b32 s27, s28, 1
    s_add_u32 s35, s35, s27
    s_lshl_b32 s35, s35, 10
    s_add_u32 s35, s35, 0x600000
    v_mov_b32 v6, 156736
    ds_read_b32 v6, v6
    s_mov_b32 s30, 7
    s_mov_b64 vcc, -1
    s_waitcnt lgkmcnt(0)
    v_mov_b32 v4, 156700
    v_mov_b32 v5, 1
    s_mov_b64 exec, 1
    ds_add_u32 v4, v5
    s_mov_b64 exec, -1
    v_readfirstlane_b32 s19, v6
    s_waitcnt vmcnt(9)
    v_mfma_f32_32x32x16_bf16 v[32:47], v[200:203], v[96:99], 0
    v_mfma_f32_32x32x16_bf16 v[48:63], v[200:203], v[100:103], 0
    v_mfma_f32_32x32x16_bf16 v[204:219], v[200:203], v[104:107], 0
    v_mfma_f32_32x32x16_bf16 v[220:235], v[200:203], v[108:111], 0
    s_nop 7
    s_nop 0
    v_max3_f32 v4, v32, v33, v34
    v_max3_f32 v5, v35, v48, v49
    v_max3_f32 v4, v4, v50, v51
    v_max3_f32 v5, v5, v204, v205
    v_max3_f32 v4, v4, v206, v207
    v_max3_f32 v5, v5, v220, v221
    v_max3_f32 v4, v4, v222, v223
    v_max_f32 v4, v4, v5
    v_mov_b32 v5, v4
    s_nop 1
    v_permlane32_swap_b32 v4, v5
    v_max_f32 v4, v4, v5
    v_sub_f32 v16, 0, v4
    v_sub_f32 v17, 0, v4
    v_pk_mov_b32 v[18:19], v[16:17], v[16:17] op_sel:[0,1]
    v_pk_mov_b32 v[20:21], v[16:17], v[16:17] op_sel:[0,1]
    v_pk_mov_b32 v[22:23], v[16:17], v[16:17] op_sel:[0,1]
    v_pk_mov_b32 v[24:25], v[16:17], v[16:17] op_sel:[0,1]
    v_pk_mov_b32 v[26:27], v[16:17], v[16:17] op_sel:[0,1]
    v_pk_mov_b32 v[28:29], v[16:17], v[16:17] op_sel:[0,1]
    v_pk_mov_b32 v[30:31], v[16:17], v[16:17] op_sel:[0,1]
    s_waitcnt vmcnt(6)
    s_nop 0
    v_mfma_f32_32x32x16_bf16 v[32:47], v[72:75], v[96:99], v[16:31]
    s_nop 7
    s_nop 3
.p2align 6
L_aloop:
    v_exp_f32 v32, v32
    v_exp_f32 v33, v33
    v_smfmac_f32_32x32x32_bf16 v[160:175], v[196:199], v[56:63], v10
    v_exp_f32 v34, v34
    v_exp_f32 v35, v35
    v_exp_f32 v36, v36
    v_mfma_f32_32x32x16_bf16 v[48:63], v[72:75], v[100:103], v[16:31]
    buffer_load_dwordx4 v[188:191], v2, s[12:15], s29 offen sc1
    v_exp_f32 v37, v37
    v_exp_f32 v38, v38
    v_exp_f32 v39, v39
    v_exp_f32 v40, v40
    v_exp_f32 v41, v41
    v_exp_f32 v42, v42
    v_smfmac_f32_32x32x32_bf16 v[112:127], v[76:79], v[32:39], v10
    v_exp_f32 v43, v43
    v_exp_f32 v44, v44
    v_exp_f32 v45, v45
    v_exp_f32 v46, v46
    v_exp_f32 v47, v47
    v_exp_f32 v48, v48
    v_exp_f32 v49, v49
    v_smfmac_f32_32x32x32_bf16 v[112:127], v[80:83], v[40:47], v10
    v_exp_f32 v50, v50
    v_exp_f32 v51, v51
    v_exp_f32 v52, v52
    v_mfma_f32_32x32x16_bf16 v[32:47], v[72:75], v[104:107], v[16:31]
    buffer_load_dwordx4 v[192:195], v3, s[12:15], s29 offen sc1
    v_exp_f32 v53, v53
    v_exp_f32 v54, v54
    v_exp_f32 v55, v55
    v_exp_f32 v56, v56
    v_exp_f32 v57, v57
    v_exp_f32 v58, v58
    v_smfmac_f32_32x32x32_bf16 v[128:143], v[76:79], v[48:55], v10
    v_exp_f32 v59, v59
    v_exp_f32 v60, v60
    v_exp_f32 v61, v61
    v_exp_f32 v62, v62
    v_exp_f32 v63, v63
    v_exp_f32 v32, v32
    v_exp_f32 v33, v33
    v_smfmac_f32_32x32x32_bf16 v[128:143], v[80:83], v[56:63], v10
    v_exp_f32 v34, v34
    v_exp_f32 v35, v35
    v_exp_f32 v36, v36
    v_mfma_f32_32x32x16_bf16 v[48:63], v[72:75], v[108:111], v[16:31]
    buffer_load_dwordx4 v[196:199], v0, s[12:15], s29 offen sc1
    v_exp_f32 v37, v37
    v_exp_f32 v38, v38
    v_exp_f32 v39, v39
    v_exp_f32 v40, v40
    v_exp_f32 v41, v41
    v_exp_f32 v42, v42
    v_smfmac_f32_32x32x32_bf16 v[144:159], v[76:79], v[32:39], v10
    s_add_u32 s29, s29, 2176
    v_exp_f32 v43, v43
    v_exp_f32 v44, v44
    v_exp_f32 v45, v45
    v_exp_f32 v46, v46
    v_exp_f32 v47, v47
    v_exp_f32 v48, v48
    v_exp_f32 v49, v49
    v_smfmac_f32_32x32x32_bf16 v[144:159], v[80:83], v[40:47], v10
    s_waitcnt vmcnt(6)
    v_exp_f32 v50, v50
    v_exp_f32 v51, v51
    v_exp_f32 v52, v52
    v_mfma_f32_32x32x16_bf16 v[32:47], v[84:87], v[96:99], v[16:31]
    s_cmp_eq_u32 s29, s54
    v_exp_f32 v53, v53
    v_exp_f32 v54, v54
    v_exp_f32 v55, v55
    v_exp_f32 v56, v56
    v_exp_f32 v57, v57
    v_exp_f32 v58, v58
    v_smfmac_f32_32x32x32_bf16 v[160:175], v[76:79], v[48:55], v10
    s_cselect_b32 s29, s37, s29
    v_exp_f32 v59, v59
    v_exp_f32 v60, v60
    v_exp_f32 v61, v61
    v_exp_f32 v62, v62
    v_exp_f32 v63, v63
    v_exp_f32 v32, v32
    v_exp_f32 v33, v33
    v_smfmac_f32_32x32x32_bf16 v[160:175], v[80:83], v[56:63], v10
    v_exp_f32 v34, v34
    v_exp_f32 v35, v35
    v_exp_f32 v36, v36
    v_mfma_f32_32x32x16_bf16 v[48:63], v[84:87], v[100:103], v[16:31]
    buffer_load_dwordx4 v[72:75], v2, s[12:15], s29 offen sc1
    v_exp_f32 v37, v37
    v_exp_f32 v38, v38
    v_exp_f32 v39, v39
    v_exp_f32 v40, v40
    v_exp_f32 v41, v41
    v_exp_f32 v42, v42
    v_smfmac_f32_32x32x32_bf16 v[112:127], v[88:91], v[32:39], v10
    v_exp_f32 v43, v43
    v_exp_f32 v44, v44
    v_exp_f32 v45, v45
    v_exp_f32 v46, v46
    v_exp_f32 v47, v47
    v_exp_f32 v48, v48
    v_exp_f32 v49, v49
    v_smfmac_f32_32x32x32_bf16 v[112:127], v[92:95], v[40:47], v10
    v_exp_f32 v50, v50
    v_exp_f32 v51, v51
    v_exp_f32 v52, v52
    v_mfma_f32_32x32x16_bf16 v[32:47], v[84:87], v[104:107], v[16:31]
    buffer_load_dwordx4 v[76:79], v3, s[12:15], s29 offen sc1
    v_exp_f32 v53, v53
    v_exp_f32 v54, v54
    v_exp_f32 v55, v55
    v_exp_f32 v56, v56
    v_exp_f32 v57, v57
    v_exp_f32 v58, v58
    v_smfmac_f32_32x32x32_bf16 v[128:143], v[88:91], v[48:55], v10
    v_exp_f32 v59, v59
    v_exp_f32 v60, v60
    v_exp_f32 v61, v61
    v_exp_f32 v62, v62
    v_exp_f32 v63, v63
    v_exp_f32 v32, v32
    v_exp_f32 v33, v33
    v_smfmac_f32_32x32x32_bf16 v[128:143], v[92:95], v[56:63], v10
    v_exp_f32 v34, v34
    v_exp_f32 v35, v35
    v_exp_f32 v36, v36
    v_mfma_f32_32x32x16_bf16 v[48:63], v[84:87], v[108:111], v[16:31]
    buffer_load_dwordx4 v[80:83], v0, s[12:15], s29 offen sc1
    v_exp_f32 v37, v37
    v_exp_f32 v38, v38
    v_exp_f32 v39, v39
    v_exp_f32 v40, v40
    v_exp_f32 v41, v41
    v_exp_f32 v42, v42
    v_smfmac_f32_32x32x32_bf16 v[144:159], v[88:91], v[32:39], v10
    s_add_u32 s29, s29, 2176
    v_exp_f32 v43, v43
    v_exp_f32 v44, v44
    v_exp_f32 v45, v45
    v_exp_f32 v46, v46
    v_exp_f32 v47, v47
    v_exp_f32 v48, v48
    v_exp_f32 v49, v49
    v_smfmac_f32_32x32x32_bf16 v[144:159], v[92:95], v[40:47], v10
    s_waitcnt vmcnt(6)
    v_exp_f32 v50, v50
    v_exp_f32 v51, v51
    v_exp_f32 v52, v52
    v_mfma_f32_32x32x16_bf16 v[32:47], v[176:179], v[96:99], v[16:31]
    s_cmp_eq_u32 s29, s54
    v_exp_f32 v53, v53
    v_exp_f32 v54, v54
    v_exp_f32 v55, v55
    v_exp_f32 v56, v56
    v_exp_f32 v57, v57
    v_exp_f32 v58, v58
    v_smfmac_f32_32x32x32_bf16 v[160:175], v[88:91], v[48:55], v10
    s_cselect_b32 s29, s37, s29
    v_exp_f32 v59, v59
    v_exp_f32 v60, v60
    v_exp_f32 v61, v61
    v_exp_f32 v62, v62
    v_exp_f32 v63, v63
    v_exp_f32 v32, v32
    v_exp_f32 v33, v33
    v_smfmac_f32_32x32x32_bf16 v[160:175], v[92:95], v[56:63], v10
    v_exp_f32 v34, v34
    v_exp_f32 v35, v35
    v_exp_f32 v36, v36
    v_mfma_f32_32x32x16_bf16 v[48:63], v[176:179], v[100:103], v[16:31]
    buffer_load_dwordx4 v[84:87], v2, s[12:15], s29 offen sc1
    v_exp_f32 v37, v37
    v_exp_f32 v38, v38
    v_exp_f32 v39, v39
    v_exp_f32 v40, v40
    v_exp_f32 v41, v41
    v_exp_f32 v42, v42
    v_smfmac_f32_32x32x32_bf16 v[112:127], v[180:183], v[32:39], v10
    v_exp_f32 v43, v43
    v_exp_f32 v44, v44
    v_exp_f32 v45, v45
    v_exp_f32 v46, v46
    v_exp_f32 v47, v47
    v_exp_f32 v48, v48
    v_exp_f32 v49, v49
    v_smfmac_f32_32x32x32_bf16 v[112:127], v[184:187], v[40:47], v10
    v_exp_f32 v50, v50
    v_exp_f32 v51, v51
    v_exp_f32 v52, v52
    v_mfma_f32_32x32x16_bf16 v[32:47], v[176:179], v[104:107], v[16:31]
    buffer_load_dwordx4 v[88:91], v3, s[12:15], s29 offen sc1
    v_exp_f32 v53, v53
    v_exp_f32 v54, v54
    v_exp_f32 v55, v55
    v_exp_f32 v56, v56
    v_exp_f32 v57, v57
    v_exp_f32 v58, v58
    v_smfmac_f32_32x32x32_bf16 v[128:143], v[180:183], v[48:55], v10
    v_exp_f32 v59, v59
    v_exp_f32 v60, v60
    v_exp_f32 v61, v61
    v_exp_f32 v62, v62
    v_exp_f32 v63, v63
    v_exp_f32 v32, v32
    v_exp_f32 v33, v33
    v_smfmac_f32_32x32x32_bf16 v[128:143], v[184:187], v[56:63], v10
    v_exp_f32 v34, v34
    v_exp_f32 v35, v35
    v_exp_f32 v36, v36
    v_mfma_f32_32x32x16_bf16 v[48:63], v[176:179], v[108:111], v[16:31]
    buffer_load_dwordx4 v[92:95], v0, s[12:15], s29 offen sc1
    v_exp_f32 v37, v37
    v_exp_f32 v38, v38
    v_exp_f32 v39, v39
    v_exp_f32 v40, v40
    v_exp_f32 v41, v41
    v_exp_f32 v42, v42
    v_smfmac_f32_32x32x32_bf16 v[144:159], v[180:183], v[32:39], v10
    s_add_u32 s29, s29, 2176
    v_exp_f32 v43, v43
    v_exp_f32 v44, v44
    v_exp_f32 v45, v45
    v_exp_f32 v46, v46
    v_exp_f32 v47, v47
    v_exp_f32 v48, v48
    v_exp_f32 v49, v49
    v_smfmac_f32_32x32x32_bf16 v[144:159], v[184:187], v[40:47], v10
    s_waitcnt vmcnt(6)
    v_exp_f32 v50, v50
    v_exp_f32 v51, v51
    v_exp_f32 v52, v52
    v_mfma_f32_32x32x16_bf16 v[32:47], v[188:191], v[96:99], v[16:31]
    s_cmp_eq_u32 s29, s54
    v_exp_f32 v53, v53
    v_exp_f32 v54, v54
    v_exp_f32 v55, v55
    v_exp_f32 v56, v56
    v_exp_f32 v57, v57
    v_exp_f32 v58, v58
    v_smfmac_f32_32x32x32_bf16 v[160:175], v[180:183], v[48:55], v10
    s_cselect_b32 s29, s37, s29
    v_exp_f32 v59, v59
    v_exp_f32 v60, v60
    v_exp_f32 v61, v61
    v_exp_f32 v62, v62
    v_exp_f32 v63, v63
    v_exp_f32 v32, v32
    v_exp_f32 v33, v33
    v_smfmac_f32_32x32x32_bf16 v[160:175], v[184:187], v[56:63], v10
    v_exp_f32 v34, v34
    v_exp_f32 v35, v35
    v_exp_f32 v36, v36
    v_mfma_f32_32x32x16_bf16 v[48:63], v[188:191], v[100:103], v[16:31]
    buffer_load_dwordx4 v[176:179], v2, s[12:15], s29 offen sc1
    v_exp_f32 v37, v37
    v_exp_f32 v38, v38
    v_exp_f32 v39, v39
    v_exp_f32 v40, v40
    v_exp_f32 v41, v41
    v_exp_f32 v42, v42
    v_smfmac_f32_32x32x32_bf16 v[112:127], v[192:195], v[32:39], v10
    v_exp_f32 v43, v43
    v_exp_f32 v44, v44
    v_exp_f32 v45, v45
    v_exp_f32 v46, v46
    v_exp_f32 v47, v47
    v_exp_f32 v48, v48
    v_exp_f32 v49, v49
    v_smfmac_f32_32x32x32_bf16 v[112:127], v[196:199], v[40:47], v10
    v_exp_f32 v50, v50
    v_exp_f32 v51, v51
    v_exp_f32 v52, v52
    v_mfma_f32_32x32x16_bf16 v[32:47], v[188:191], v[104:107], v[16:31]
    buffer_load_dwordx4 v[180:183], v3, s[12:15], s29 offen sc1
    v_exp_f32 v53, v53
    v_exp_f32 v54, v54
    v_exp_f32 v55, v55
    v_exp_f32 v56, v56
    v_exp_f32 v57, v57
    v_exp_f32 v58, v58
    v_smfmac_f32_32x32x32_bf16 v[128:143], v[192:195], v[48:55], v10
    v_exp_f32 v59, v59
    v_exp_f32 v60, v60
    v_exp_f32 v61, v61
    v_exp_f32 v62, v62
    v_exp_f32 v63, v63
    v_exp_f32 v32, v32
    v_exp_f32 v33, v33
    v_smfmac_f32_32x32x32_bf16 v[128:143], v[196:199], v[56:63], v10
    v_exp_f32 v34, v34
    v_exp_f32 v35, v35
    v_exp_f32 v36, v36
    v_mfma_f32_32x32x16_bf16 v[48:63], v[188:191], v[108:111], v[16:31]
    buffer_load_dwordx4 v[184:187], v0, s[12:15], s29 offen sc1
    v_exp_f32 v37, v37
    v_exp_f32 v38, v38
    v_exp_f32 v39, v39
    v_exp_f32 v40, v40
    v_exp_f32 v41, v41
    v_exp_f32 v42, v42
    v_smfmac_f32_32x32x32_bf16 v[144:159], v[192:195], v[32:39], v10
    s_add_u32 s29, s29, 2176
    v_exp_f32 v43, v43
    v_exp_f32 v44, v44
    v_exp_f32 v45, v45
    v_exp_f32 v46, v46
    v_exp_f32 v47, v47
    v_exp_f32 v48, v48
    v_exp_f32 v49, v49
    v_smfmac_f32_32x32x32_bf16 v[144:159], v[196:199], v[40:47], v10
    s_waitcnt vmcnt(6)
    v_exp_f32 v50, v50
    v_exp_f32 v51, v51
    v_exp_f32 v52, v52
    v_mfma_f32_32x32x16_bf16 v[32:47], v[72:75], v[96:99], v[16:31]
    s_cmp_eq_u32 s29, s54
    v_exp_f32 v53, v53
    v_exp_f32 v54, v54
    v_exp_f32 v55, v55
    v_exp_f32 v56, v56
    v_exp_f32 v57, v57
    v_exp_f32 v58, v58
    v_smfmac_f32_32x32x32_bf16 v[160:175], v[192:195], v[48:55], v10
    s_cselect_b32 s29, s37, s29
    s_sub_u32 s30, s30, 1
    v_exp_f32 v59, v59
    v_exp_f32 v60, v60
    v_exp_f32 v61, v61
    v_exp_f32 v62, v62
    v_exp_f32 v63, v63
    s_cbranch_vccnz L_afirst
    s_cbranch_scc0 L_aloop
    s_nop 0
    v_smfmac_f32_32x32x32_bf16 v[160:175], v[196:199], v[56:63], v10
    ds_write_b128 v11, v[112:115] offset:0
    ds_write_b128 v11, v[116:119] offset:1024
    ds_write_b32 v12, v120 offset:2048
    ds_write_b128 v11, v[128:131] offset:2304
    ds_write_b128 v11, v[132:135] offset:3328
    ds_write_b32 v12, v136 offset:4352
    s_mov_b32 s29, 0
    s_mov_b32 s30, 64
    s_waitcnt lgkmcnt(0)
    s_barrier
    ds_read_b32 v40, v14 offset:2048
    ds_read_b128 v[32:35], v13 offset:0
    ds_read_b128 v[36:39], v13 offset:1024
    ds_read_b32 v56, v14 offset:4352
    ds_read_b128 v[48:51], v13 offset:2304
    ds_read_b128 v[52:55], v13 offset:3328
    s_waitcnt lgkmcnt(3)
    v_add_f32 v152, v152, v40
    v_pk_add_f32 v[144:145], v[144:145], v[32:33]
    v_pk_add_f32 v[146:147], v[146:147], v[34:35]
    v_pk_add_f32 v[148:149], v[148:149], v[36:37]
    v_pk_add_f32 v[150:151], v[150:151], v[38:39]
    v_rcp_f32 v120, v152
    s_nop 0
    v_mul_f32 v112, v144, v120
    v_mul_f32 v113, v145, v120
    v_mul_f32 v114, v146, v120
    v_mul_f32 v115, v147, v120
    v_mul_f32 v116, v148, v120
    v_mul_f32 v117, v149, v120
    v_mul_f32 v118, v150, v120
    v_mul_f32 v119, v151, v120
    v_cvt_pk_bf16_f32 v64, v112, v113
    v_cvt_pk_bf16_f32 v65, v114, v115
    v_cvt_pk_bf16_f32 v66, v116, v117
    v_cvt_pk_bf16_f32 v67, v118, v119
    buffer_store_dwordx4 v[64:67], v2, s[12:15], s35 offen offset:0 sc1
    s_waitcnt lgkmcnt(0)
    v_add_f32 v168, v168, v56
    v_pk_add_f32 v[160:161], v[160:161], v[48:49]
    v_pk_add_f32 v[162:163], v[162:163], v[50:51]
    v_pk_add_f32 v[164:165], v[164:165], v[52:53]
    v_pk_add_f32 v[166:167], v[166:167], v[54:55]
    v_rcp_f32 v136, v168
    s_nop 0
    v_mul_f32 v128, v160, v136
    v_mul_f32 v129, v161, v136
    v_mul_f32 v130, v162, v136
    v_mul_f32 v131, v163, v136
    v_mul_f32 v132, v164, v136
    v_mul_f32 v133, v165, v136
    v_mul_f32 v134, v166, v136
    v_mul_f32 v135, v167, v136
    v_cvt_pk_bf16_f32 v68, v128, v129
    v_cvt_pk_bf16_f32 v69, v130, v131
    v_cvt_pk_bf16_f32 v70, v132, v133
    v_cvt_pk_bf16_f32 v71, v134, v135
    buffer_store_dwordx4 v[68:71], v2, s[12:15], s35 offen offset:1024 sc1
    v_max3_f32 v4, |v144|, |v145|, |v146|
    v_max3_f32 v5, |v147|, |v148|, |v149|
    v_max3_f32 v4, v4, |v150|, |v151|
    s_mov_b32 s24, 0x21800000
    s_mov_b32 s25, 0x53800000
    s_mov_b32 s26, 0x7b800000
    v_add_f32 v4, v4, v5
    v_cmp_nlt_f32 vcc, s24, v152
    v_cmp_ngt_f32 s[38:39], s25, v152
    v_cmp_ngt_f32 s[40:41], s26, v4
    s_nop 1
    s_or_b64 vcc, vcc, s[38:39]
    s_or_b64 vcc, vcc, s[40:41]
    s_cbranch_vccnz L_a_slow0
L_a_ok0:
    v_max3_f32 v4, |v160|, |v161|, |v162|
    v_max3_f32 v5, |v163|, |v164|, |v165|
    v_max3_f32 v4, v4, |v166|, |v167|
    s_mov_b32 s24, 0x21800000
    s_mov_b32 s25, 0x53800000
    s_mov_b32 s26, 0x7b800000
    v_add_f32 v4, v4, v5
    v_cmp_nlt_f32 vcc, s24, v168
    v_cmp_ngt_f32 s[38:39], s25, v168
    v_cmp_ngt_f32 s[40:41], s26, v4
    s_nop 1
    s_or_b64 vcc, vcc, s[38:39]
    s_or_b64 vcc, vcc, s[40:41]
    s_cbranch_vccnz L_a_slow1
L_a_ok1:
    s_waitcnt vmcnt(0)
    s_lshl_b32 s35, s18, 8
    s_lshl_b32 s24, s17, 5
    s_add_u32 s35, s35, s24
    s_add_u32 s35, s35, 0x46000
    s_barrier
    s_cmp_lg_u32 s16, 0
    s_cbranch_scc1 L_a_noflag
    v_mov_b32 v4, s19
    v_mov_b32 v5, 0
    s_mov_b64 exec, 1
    buffer_store_dword v4, v5, s[12:15], s35 offen sc1
    s_mov_b64 exec, -1
L_a_noflag:
    v_and_b32 v4, 7, v1
    v_lshlrev_b32 v4, 5, v4
    s_lshl_b32 s26, s18, 8
    s_add_u32 s26, s26, 0x46000
    s_and_b32 s24, s16, 1
    s_lshr_b32 s25, s16, 1
    s_lshl_b32 s33, s24, 15
    s_lshl_b32 s34, s18, 1
    s_add_u32 s34, s34, s24
    s_lshl_b32 s34, s34, 16
    s_add_u32 s34, s34, 0x600000
    s_mul_i32 s40, s25, 2048
    s_add_u32 s40, s40, 0
    s_mul_i32 s41, s25, 2048
    s_add_u32 s41, s41, 8192
    s_mul_i32 s42, s25, 2048
    s_add_u32 s42, s42, 16384
    s_mul_i32 s43, s25, 2048
    s_add_u32 s43, s43, 24576
    s_cmp_lg_u32 s16, 0
    s_cbranch_scc1 tp_7
    s_mov_b32 s36, 400000
poll_8:
    buffer_load_dword v5, v4, s[12:15], s26 offen sc1
    s_waitcnt vmcnt(0)
    v_cmp_ne_u32 vcc, s19, v5
    s_nop 1
    s_cbranch_vccz polld_9
    s_mov_b64 exec, vcc
    s_sub_u32 s36, s36, 1
    s_cbranch_scc1 polld_9
    s_sleep 1
    s_branch poll_8
polld_9:
    s_mov_b64 exec, -1
tp_7:
    s_barrier
    s_add_u32 m0, s33, s40
    s_add_u32 s24, s34, s40
    buffer_load_dwordx4 v2, s[12:15], s24 offen offset:0 sc1 lds
    buffer_load_dwordx4 v2, s[12:15], s24 offen offset:1024 sc1 lds
    s_add_u32 m0, s33, s41
    s_add_u32 s24, s34, s41
    buffer_load_dwordx4 v2, s[12:15], s24 offen offset:0 sc1 lds
    buffer_load_dwordx4 v2, s[12:15], s24 offen offset:1024 sc1 lds
    s_add_u32 m0, s33, s42
    s_add_u32 s24, s34, s42
    buffer_load_dwordx4 v2, s[12:15], s24 offen offset:0 sc1 lds
    buffer_load_dwordx4 v2, s[12:15], s24 offen offset:1024 sc1 lds
    s_add_u32 m0, s33, s43
    s_add_u32 s24, s34, s43
    buffer_load_dwordx4 v2, s[12:15], s24 offen offset:0 sc1 lds
    buffer_load_dwordx4 v2, s[12:15], s24 offen offset:1024 sc1 lds
    s_waitcnt vmcnt(6)
    s_barrier
    s_waitcnt vmcnt(4)
    s_barrier
    s_waitcnt vmcnt(2)
    s_barrier
    s_waitcnt vmcnt(0)
    s_barrier
    s_endpgm
L_afirst:
    v_mov_b32 v4, 156708
    s_mov_b32 s36, 400000
tw_10:
    ds_read_b32 v5, v4
    s_waitcnt lgkmcnt(0)
    v_readfirstlane_b32 s24, v5
    s_nop 1
    s_cmp_ge_u32 s24, 1
    s_cbranch_scc1 twd_11
    s_sub_u32 s36, s36, 1
    s_cbranch_scc1 twd_11
    s_sleep 1
    s_branch tw_10
twd_11:
    s_mov_b64 vcc, 0
    s_branch L_aloop
L_a_slow0:
    s_waitcnt vmcnt(0) lgkmcnt(0)
    v_mov_b32 v9, 0xfe967699
    v_mov_b32 v7, v9
    s_mov_b32 s33, s29
    s_mov_b32 s34, 0
sp1_12:
    buffer_load_dwordx4 v[72:75], v2, s[12:15], s33 offen sc1
    s_waitcnt vmcnt(0)
    s_nop 1
    v_mfma_f32_32x32x16_bf16 v[32:47], v[72:75], v[104:107], 0
    s_add_u32 s33, s33, 0x880
    s_add_u32 s34, s34, 1
    s_nop 15
    v_max3_f32 v7, v7, v32, v33
    v_max3_f32 v7, v7, v34, v35
    v_max3_f32 v7, v7, v36, v37
    v_max3_f32 v7, v7, v38, v39
    v_max3_f32 v7, v7, v40, v41
    v_max3_f32 v7, v7, v42, v43
    v_max3_f32 v7, v7, v44, v45
    v_max3_f32 v7, v7, v46, v47
    s_cmp_lt_u32 s34, s30
    s_cbranch_scc1 sp1_12
    v_mov_b32 v8, v7
    s_nop 1
    v_permlane32_swap_b32 v7, v8
    v_max_f32 v7, v7, v8
    v_mov_b32 v144, 0
    v_mov_b32 v145, 0
    v_mov_b32 v146, 0
    v_mov_b32 v147, 0
    v_mov_b32 v148, 0
    v_mov_b32 v149, 0
    v_mov_b32 v150, 0
    v_mov_b32 v151, 0
    v_mov_b32 v152, 0
    v_mov_b32 v153, 0
    v_mov_b32 v154, 0
    v_mov_b32 v155, 0
    v_mov_b32 v156, 0
    v_mov_b32 v157, 0
    v_mov_b32 v158, 0
    v_mov_b32 v159, 0
    s_mov_b32 s33, s29
    s_mov_b32 s34, 0
sp2_13:
    buffer_load_dwordx4 v[72:75], v2, s[12:15], s33 offen sc1
    buffer_load_dwordx4 v[76:79], v3, s[12:15], s33 offen sc1
    buffer_load_dwordx4 v[80:83], v0, s[12:15], s33 offen sc1
    s_waitcnt vmcnt(0)
    s_nop 1
    v_mfma_f32_32x32x16_bf16 v[32:47], v[72:75], v[104:107], 0
    s_add_u32 s33, s33, 0x880
    s_add_u32 s34, s34, 1
    s_nop 15
    v_sub_f32 v32, v32, v7
    v_sub_f32 v33, v33, v7
    v_sub_f32 v34, v34, v7
    v_sub_f32 v35, v35, v7
    v_sub_f32 v36, v36, v7
    v_sub_f32 v37, v37, v7
    v_sub_f32 v38, v38, v7
    v_sub_f32 v39, v39, v7
    v_sub_f32 v40, v40, v7
    v_sub_f32 v41, v41, v7
    v_sub_f32 v42, v42, v7
    v_sub_f32 v43, v43, v7
    v_sub_f32 v44, v44, v7
    v_sub_f32 v45, v45, v7
    v_sub_f32 v46, v46, v7
    v_sub_f32 v47, v47, v7
    v_exp_f32 v32, v32
    v_exp_f32 v33, v33
    v_exp_f32 v34, v34
    v_exp_f32 v35, v35
    v_exp_f32 v36, v36
    v_exp_f32 v37, v37
    v_exp_f32 v38, v38
    v_exp_f32 v39, v39
    v_exp_f32 v40, v40
    v_exp_f32 v41, v41
    v_exp_f32 v42, v42
    v_exp_f32 v43, v43
    v_exp_f32 v44, v44
    v_exp_f32 v45, v45
    v_exp_f32 v46, v46
    v_exp_f32 v47, v47
    s_nop 2
    v_smfmac_f32_32x32x32_bf16 v[144:159], v[76:79], v[32:39], v10
    v_smfmac_f32_32x32x32_bf16 v[144:159], v[80:83], v[40:47], v10
    s_cmp_lt_u32 s34, s30
    s_nop 15
    s_cbranch_scc1 sp2_13
    s_branch L_a_re0
L_a_re0:
    v_rcp_f32 v120, v152
    s_nop 0
    v_mul_f32 v112, v144, v120
    v_mul_f32 v113, v145, v120
    v_mul_f32 v114, v146, v120
    v_mul_f32 v115, v147, v120
    v_mul_f32 v116, v148, v120
    v_mul_f32 v117, v149, v120
    v_mul_f32 v118, v150, v120
    v_mul_f32 v119, v151, v120
    v_cvt_pk_bf16_f32 v64, v112, v113
    v_cvt_pk_bf16_f32 v65, v114, v115
    v_cvt_pk_bf16_f32 v66, v116, v117
    v_cvt_pk_bf16_f32 v67, v118, v119
    buffer_store_dwordx4 v[64:67], v2, s[12:15], s35 offen offset:0 sc1
    s_branch L_a_ok0
L_a_slow1:
    s_waitcnt vmcnt(0) lgkmcnt(0)
    v_mov_b32 v9, 0xfe967699
    v_mov_b32 v7, v9
    s_mov_b32 s33, s29
    s_mov_b32 s34, 0
sp1_14:
    buffer_load_dwordx4 v[72:75], v2, s[12:15], s33 offen sc1
    s_waitcnt vmcnt(0)
    s_nop 1
    v_mfma_f32_32x32x16_bf16 v[32:47], v[72:75], v[108:111], 0
    s_add_u32 s33, s33, 0x880
    s_add_u32 s34, s34, 1
    s_nop 15
    v_max3_f32 v7, v7, v32, v33
    v_max3_f32 v7, v7, v34, v35
    v_max3_f32 v7, v7, v36, v37
    v_max3_f32 v7, v7, v38, v39
    v_max3_f32 v7, v7, v40, v41
    v_max3_f32 v7, v7, v42, v43
    v_max3_f32 v7, v7, v44, v45
    v_max3_f32 v7, v7, v46, v47
    s_cmp_lt_u32 s34, s30
    s_cbranch_scc1 sp1_14
    v_mov_b32 v8, v7
    s_nop 1
    v_permlane32_swap_b32 v7, v8
    v_max_f32 v7, v7, v8
    v_mov_b32 v160, 0
    v_mov_b32 v161, 0
    v_mov_b32 v162, 0
    v_mov_b32 v163, 0
    v_mov_b32 v164, 0
    v_mov_b32 v165, 0
    v_mov_b32 v166, 0
    v_mov_b32 v167, 0
    v_mov_b32 v168, 0
    v_mov_b32 v169, 0
    v_mov_b32 v170, 0
    v_mov_b32 v171, 0
    v_mov_b32 v172, 0
    v_mov_b32 v173, 0
    v_mov_b32 v174, 0
    v_mov_b32 v175, 0
    s_mov_b32 s33, s29
    s_mov_b32 s34, 0
sp2_15:
    buffer_load_dwordx4 v[72:75], v2, s[12:15], s33 offen sc1
    buffer_load_dwordx4 v[76:79], v3, s[12:15], s33 offen sc1
    buffer_load_dwordx4 v[80:83], v0, s[12:15], s33 offen sc1
    s_waitcnt vmcnt(0)
    s_nop 1
    v_mfma_f32_32x32x16_bf16 v[32:47], v[72:75], v[108:111], 0
    s_add_u32 s33, s33, 0x880
    s_add_u32 s34, s34, 1
    s_nop 15
    v_sub_f32 v32, v32, v7
    v_sub_f32 v33, v33, v7
    v_sub_f32 v34, v34, v7
    v_sub_f32 v35, v35, v7
    v_sub_f32 v36, v36, v7
    v_sub_f32 v37, v37, v7
    v_sub_f32 v38, v38, v7
    v_sub_f32 v39, v39, v7
    v_sub_f32 v40, v40, v7
    v_sub_f32 v41, v41, v7
    v_sub_f32 v42, v42, v7
    v_sub_f32 v43, v43, v7
    v_sub_f32 v44, v44, v7
    v_sub_f32 v45, v45, v7
    v_sub_f32 v46, v46, v7
    v_sub_f32 v47, v47, v7
    v_exp_f32 v32, v32
    v_exp_f32 v33, v33
    v_exp_f32 v34, v34
    v_exp_f32 v35, v35
    v_exp_f32 v36, v36
    v_exp_f32 v37, v37
    v_exp_f32 v38, v38
    v_exp_f32 v39, v39
    v_exp_f32 v40, v40
    v_exp_f32 v41, v41
    v_exp_f32 v42, v42
    v_exp_f32 v43, v43
    v_exp_f32 v44, v44
    v_exp_f32 v45, v45
    v_exp_f32 v46, v46
    v_exp_f32 v47, v47
    s_nop 2
    v_smfmac_f32_32x32x32_bf16 v[160:175], v[76:79], v[32:39], v10
    v_smfmac_f32_32x32x32_bf16 v[160:175], v[80:83], v[40:47], v10
    s_cmp_lt_u32 s34, s30
    s_nop 15
    s_cbranch_scc1 sp2_15
    s_branch L_a_re1
L_a_re1:
    v_rcp_f32 v136, v168
    s_nop 0
    v_mul_f32 v128, v160, v136
    v_mul_f32 v129, v161, v136
    v_mul_f32 v130, v162, v136
    v_mul_f32 v131, v163, v136
    v_mul_f32 v132, v164, v136
    v_mul_f32 v133, v165, v136
    v_mul_f32 v134, v166, v136
    v_mul_f32 v135, v167, v136
    v_cvt_pk_bf16_f32 v68, v128, v129
    v_cvt_pk_bf16_f32 v69, v130, v131
    v_cvt_pk_bf16_f32 v70, v132, v133
    v_cvt_pk_bf16_f32 v71, v134, v135
    buffer_store_dwordx4 v[68:71], v2, s[12:15], s35 offen offset:1024 sc1
    s_branch L_a_ok1
L_code_end:
    s_endpgm
.section .rodata,"a"
.p2align 6
.amdhsa_kernel gated_mix__grouped_kv_mqa__sliding_block__prompt_kernel
  .amdhsa_next_free_vgpr 256
  .amdhsa_next_free_sgpr 102
  .amdhsa_accum_offset 256
  .amdhsa_group_segment_fixed_size 0
  .amdhsa_kernarg_size 96
  .amdhsa_user_sgpr_count 2
  .amdhsa_user_sgpr_kernarg_segment_ptr 1
  .amdhsa_system_sgpr_workgroup_id_x 1
.end_amdhsa_kernel
```
